```python
import torch

def _softmax(x, axis=-1):
    return torch.softmax(x, dim=axis)
def _gelu(x):
    return torch.nn.functional.gelu(x, approximate="tanh")
def _silu(x):
    return torch.nn.functional.silu(x)
def _sigmoid(x):
    return torch.sigmoid(x)
def _layernorm(x, axis=-1, eps=1e-5):
    m = x.mean(dim=axis, keepdim=True)
    v = x.var(dim=axis, keepdim=True, unbiased=False)
    return (x - m) / torch.sqrt(v + eps)
def _scatter_add(tgt, idx, src, axis=0):
    return tgt.clone().index_add_(axis, idx, src)
def _segment_sum(src, seg, n):
    out = torch.zeros((n,) + src.shape[1:], dtype=src.dtype)
    return out.index_add_(0, seg, src)
def _pad(x, pw):
    flat = tuple(v for pair in reversed(pw) for v in pair)
    return torch.nn.functional.pad(x, flat)

kernel_name = 'sequential_preLN__mha_block_cached__dense_activation_gelu__decode'

def setup_inputs():

    _w = (lambda a: (lambda t: t.to(torch.bfloat16) if t.is_floating_point() else t)(torch.as_tensor(a)))
    def _A_setup():
        B, Sq, D = 4, 1, 640
        H, Sk, Dh = 32, 8192, 192
        return {
            "x": _w((lambda *s: torch.randn(*s, dtype=torch.bfloat16) * 0.1)(B, Sq, D)),
            "k_cache": _w((lambda *s: torch.randn(*s, dtype=torch.bfloat16) * 1.6)(B, H, Sk, Dh)),
            "v_cache": _w((lambda *s: torch.randn(*s, dtype=torch.bfloat16) * 1.6)(B, H, Sk, Dh)),
            "wq": _w((lambda *s: torch.randn(*s, dtype=torch.bfloat16) * 1.6)(D, H * Dh) * (D ** -0.5)),
            "wo": _w((lambda *s: torch.randn(*s, dtype=torch.bfloat16) * 1.6)(H * Dh, D) * ((H * Dh) ** -0.5)),
        }
    _A_in = _A_setup()

    def _B_setup():
        B, S, D, F = 4, 1, 640, 1536
        return {
            "x": _w((lambda *s: torch.randn(*s, dtype=torch.bfloat16) * 0.1)(B, S, D)),
            "w1": _w((lambda *s: torch.randn(*s, dtype=torch.bfloat16) * 3.2)(D, F) * (D ** -0.5)),
            "b1": _w((lambda *s: torch.randn(*s, dtype=torch.bfloat16) * 3.2)(F) * 0.01),
            "w2": _w((lambda *s: torch.randn(*s, dtype=torch.bfloat16) * 3.2)(F, D) * (F ** -0.5)),
            "b2": _w((lambda *s: torch.randn(*s, dtype=torch.bfloat16) * 3.2)(D) * 0.01),
        }
    _B_in = _B_setup()

    return {
        "A_x": _A_in["x"],
        "A_k_cache": _A_in["k_cache"],
        "A_v_cache": _A_in["v_cache"],
        "A_wq": _A_in["wq"],
        "A_wo": _A_in["wo"],
        "B_x": _B_in["x"],
        "B_w1": _B_in["w1"],
        "B_b1": _B_in["b1"],
        "B_w2": _B_in["w2"],
        "B_b2": _B_in["b2"],
    }

def reference(A_x, A_k_cache, A_v_cache, A_wq, A_wo, B_x, B_w1, B_b1, B_w2, B_b2):
    def _A_ref(x, k_cache, v_cache, wq, wo):
        B, Sq, D = x.shape
        H, Dh = 32, 192
        q = (lambda x, *d: x.permute(*d))((x @ wq).reshape(B, Sq, H, Dh), 0, 2, 1, 3)
        scores = torch.einsum("bhqd,bhkd->bhqk", q, k_cache) * (Dh ** -0.5)
        p = _softmax(scores, axis=-1)
        o = torch.einsum("bhqk,bhkd->bhqd", p, v_cache)
        return (lambda x, *d: x.permute(*d))(o, 0, 2, 1, 3).reshape(B, Sq, H * Dh) @ wo

    def _B_ref(x, w1, b1, w2, b2):
        h = torch.einsum("bsd,df->bsf", x, w1) + b1
        h = _gelu(h)
        return torch.einsum("bsf,fd->bsd", h, w2) + b2

    x = A_x
    h = x + _A_ref(_layernorm(x, axis=-1), A_k_cache, A_v_cache, A_wq, A_wo)
    h2 = h + _B_ref(_layernorm(h, axis=-1), B_w1, B_b1, B_w2, B_b2)
    return h2
```

```asm
; @launch grid=(256,1,1) block=(512,1,1) lds=128320
.amdgcn_target "amdgcn-amd-amdhsa--gfx950"
.text
.globl sequential_preLN__mha_block_cached__dense_activation_gelu__decode_kernel
.p2align 8
.type sequential_preLN__mha_block_cached__dense_activation_gelu__decode_kernel,@function
sequential_preLN__mha_block_cached__dense_activation_gelu__decode_kernel:
    s_cmp_ge_u32 s2, 256
    s_cbranch_scc1 L_end
    s_load_dwordx2 s[24:25], s[0:1], 0
    s_load_dwordx2 s[28:29], s[0:1], 24
    s_load_dwordx2 s[8:9], s[0:1], 8
    v_lshrrev_b32 v1, 6, v0
    v_and_b32 v0, 63, v0
    v_readfirstlane_b32 s3, v1
    s_and_b32 s5, s2, 7
    s_lshr_b32 s4, s2, 3
    s_cmp_ge_u32 s3, 4
    s_cbranch_scc1 L_stream
    s_mov_b32 s26, 5120
    s_mov_b32 s27, 0x20000
    s_mov_b32 s30, 7864320
    s_mov_b32 s31, 0x20000
L_h0:
    v_lshrrev_b32 v2, 2, v0
    v_and_b32 v1, 3, v2
    v_mul_u32_u24 v1, 1280, v1
    v_lshrrev_b32 v4, 4, v0
    v_and_b32 v3, 3, v0
    v_lshl_add_u32 v3, v4, 2, v3
    v_lshl_add_u32 v3, v3, 4, v1
    v_lshl_add_u32 v4, v4, 3, v1
    v_lshrrev_b32 v5, 3, v0
    v_mul_u32_u24 v5, 12288, v5
    v_and_b32 v6, 7, v0
    v_lshl_add_u32 v5, v6, 4, v5
    s_add_u32 s80, s5, s4
    s_and_b32 s80, s80, 7
    s_and_b32 s75, s80, 1
    s_lshl_b32 s75, s75, 2
    s_add_u32 s75, s75, s3
    s_mul_i32 s72, s75, 160
    s_mul_i32 s73, s75, 983040
    s_mul_i32 s74, s4, 384
    s_add_u32 s73, s73, s74
    s_lshr_b32 s74, s80, 1
    s_lshl_b32 s74, s74, 7
    s_add_u32 s73, s73, s74
    s_mul_i32 s74, s3, 24576
    s_mul_i32 s81, s4, 6144
    s_waitcnt lgkmcnt(0)
    s_cmp_ge_u32 s80, 6
    s_cbranch_scc1 L_nold
    s_cmp_lg_u32 s3, 3
    s_cbranch_scc1 L_nox
    buffer_load_dwordx4 v[20:23], v3, s[24:27], 0 offen offset:0
    buffer_load_dwordx4 v[24:27], v3, s[24:27], 0 offen offset:256
    buffer_load_dwordx4 v[28:31], v3, s[24:27], 0 offen offset:512
    buffer_load_dwordx4 v[32:35], v3, s[24:27], 0 offen offset:768
    buffer_load_dwordx4 v[36:39], v3, s[24:27], 0 offen offset:1024
L_nox:
    s_mov_b32 m0, s74
    s_nop 0
    buffer_load_dwordx4 v5, s[28:31], s73 offen nt lds
    s_add_u32 s73, s73, 98304
    s_add_u32 s74, s74, 1024
    s_mov_b32 m0, s74
    s_nop 0
    buffer_load_dwordx4 v5, s[28:31], s73 offen nt lds
    s_add_u32 s73, s73, 98304
    s_add_u32 s74, s74, 1024
    s_mov_b32 m0, s74
    s_nop 0
    buffer_load_dwordx4 v5, s[28:31], s73 offen nt lds
    s_add_u32 s73, s73, 98304
    s_add_u32 s74, s74, 1024
    s_mov_b32 m0, s74
    s_nop 0
    buffer_load_dwordx4 v5, s[28:31], s73 offen nt lds
    s_add_u32 s73, s73, 98304
    s_add_u32 s74, s74, 1024
    s_mov_b32 m0, s74
    s_nop 0
    buffer_load_dwordx4 v5, s[28:31], s73 offen nt lds
    s_add_u32 s73, s73, 98304
    s_add_u32 s74, s74, 1024
    s_mov_b32 m0, s74
    s_nop 0
    buffer_load_dwordx4 v5, s[28:31], s73 offen nt lds
    s_add_u32 s73, s73, 98304
    s_add_u32 s74, s74, 1024
    s_mov_b32 m0, s74
    s_nop 0
    buffer_load_dwordx4 v5, s[28:31], s73 offen nt lds
    s_add_u32 s73, s73, 98304
    s_add_u32 s74, s74, 1024
    s_mov_b32 m0, s74
    s_nop 0
    buffer_load_dwordx4 v5, s[28:31], s73 offen nt lds
    s_add_u32 s73, s73, 98304
    s_add_u32 s74, s74, 1024
    s_mov_b32 m0, s74
    s_nop 0
    buffer_load_dwordx4 v5, s[28:31], s73 offen nt lds
    s_add_u32 s73, s73, 98304
    s_add_u32 s74, s74, 1024
    s_mov_b32 m0, s74
    s_nop 0
    buffer_load_dwordx4 v5, s[28:31], s73 offen nt lds
L_nold:
    s_barrier
L_nob:
    s_load_dwordx2 s[20:21], s[0:1], 88
    s_load_dwordx2 s[16:17], s[0:1], 96
    s_load_dwordx2 s[32:33], s[0:1], 32
    s_load_dwordx2 s[36:37], s[0:1], 48
    s_load_dwordx2 s[40:41], s[0:1], 64
    s_load_dwordx2 s[44:45], s[0:1], 80
    s_load_dwordx2 s[48:49], s[0:1], 56
    s_load_dwordx2 s[52:53], s[0:1], 72
    s_mov_b32 s22, 256
    s_mov_b32 s23, 0x20000
    s_mov_b32 s18, 4194304
    s_mov_b32 s19, 0x20000
    s_mov_b32 s34, 7864320
    s_mov_b32 s35, 0x20000
    s_mov_b32 s38, 1966080
    s_mov_b32 s39, 0x20000
    s_mov_b32 s42, 1966080
    s_mov_b32 s43, 0x20000
    s_mov_b32 s46, 5120
    s_mov_b32 s47, 0x20000
    s_mov_b32 s50, 3072
    s_mov_b32 s51, 0x20000
    s_mov_b32 s54, 1280
    s_mov_b32 s55, 0x20000
    s_mov_b32 s70, 0xffff0000
    s_mov_b32 s71, 0x3fb8aa3b
    s_mov_b32 s68, 16384
    s_waitcnt lgkmcnt(0)
    s_cmp_lg_u32 s3, 1
    s_cbranch_scc1 L_h1
    s_load_dword s64, s[20:21], 192
    s_waitcnt lgkmcnt(0)
    s_cmp_lg_u32 s64, 0
    s_cbranch_scc1 L_ngot
    s_load_dword s64, s[20:21], 0
    s_waitcnt lgkmcnt(0)
    s_cmp_lg_u32 s64, 0
    s_cbranch_scc1 L_ngot
    s_load_dword s64, s[20:21], 64
    s_waitcnt lgkmcnt(0)
    s_cmp_lg_u32 s64, 0
    s_cbranch_scc1 L_ngot
    s_load_dword s64, s[20:21], 128
    s_waitcnt lgkmcnt(0)
    s_cmp_lg_u32 s64, 0
    s_cbranch_scc1 L_ngot
    v_mov_b32 v7, 0
L_nv:
    buffer_load_dword v6, v7, s[20:23], 0 offen sc1
    s_waitcnt vmcnt(0)
    v_readfirstlane_b32 s64, v6
    s_sub_u32 s68, s68, 1
    s_cselect_b32 s64, 1, s64
    s_cmp_eq_u32 s64, 0
    s_cbranch_scc1 L_nv
    s_mov_b32 s68, 16384
L_ngot:
    v_mov_b32 v6, s64
    v_mov_b32 v7, 112384
    ds_write_b32 v7, v6 offset:4
L_h1:
    s_cmp_ge_u32 s80, 6
    s_cbranch_scc1 L_nop
    s_or_b32 s73, s80, s3
    s_cbranch_scc1 L_noct
    s_mul_i32 s73, s4, 4352
    s_add_u32 s73, s73, 3407872
    v_mov_b32 v6, 0
    v_lshlrev_b32 v7, 7, v0
    s_mov_b64 exec, 3
    buffer_store_dword v6, v7, s[16:19], s73 offen sc1
    s_mov_b64 exec, -1
L_noct:
    s_cmp_lg_u32 s3, 3
    s_cbranch_scc1 L_xw
    s_waitcnt vmcnt(10)
    s_mov_b32 s75, 0x3f803f80
    v_dot2_f32_bf16 v6, v20, s75, 0
    v_dot2_f32_bf16 v7, v21, s75, 0
    v_dot2_f32_bf16 v6, v22, s75, v6
    v_dot2_f32_bf16 v7, v23, s75, v7
    v_dot2_f32_bf16 v6, v24, s75, v6
    v_dot2_f32_bf16 v7, v25, s75, v7
    v_dot2_f32_bf16 v6, v26, s75, v6
    v_dot2_f32_bf16 v7, v27, s75, v7
    v_dot2_f32_bf16 v6, v28, s75, v6
    v_dot2_f32_bf16 v7, v29, s75, v7
    v_dot2_f32_bf16 v6, v30, s75, v6
    v_dot2_f32_bf16 v7, v31, s75, v7
    v_dot2_f32_bf16 v6, v32, s75, v6
    v_dot2_f32_bf16 v7, v33, s75, v7
    v_dot2_f32_bf16 v6, v34, s75, v6
    v_dot2_f32_bf16 v7, v35, s75, v7
    v_dot2_f32_bf16 v6, v36, s75, v6
    v_dot2_f32_bf16 v7, v37, s75, v7
    v_dot2_f32_bf16 v6, v38, s75, v6
    v_dot2_f32_bf16 v7, v39, s75, v7
    v_lshlrev_b32 v40, 16, v20
    v_and_b32 v41, s70, v20
    v_lshlrev_b32 v42, 16, v21
    v_and_b32 v43, s70, v21
    v_lshlrev_b32 v44, 16, v22
    v_and_b32 v45, s70, v22
    v_lshlrev_b32 v46, 16, v23
    v_and_b32 v47, s70, v23
    v_lshlrev_b32 v48, 16, v24
    v_and_b32 v49, s70, v24
    v_lshlrev_b32 v50, 16, v25
    v_and_b32 v51, s70, v25
    v_lshlrev_b32 v52, 16, v26
    v_and_b32 v53, s70, v26
    v_lshlrev_b32 v54, 16, v27
    v_and_b32 v55, s70, v27
    v_lshlrev_b32 v56, 16, v28
    v_and_b32 v57, s70, v28
    v_lshlrev_b32 v58, 16, v29
    v_and_b32 v59, s70, v29
    v_lshlrev_b32 v60, 16, v30
    v_and_b32 v61, s70, v30
    v_lshlrev_b32 v62, 16, v31
    v_and_b32 v63, s70, v31
    v_lshlrev_b32 v64, 16, v32
    v_and_b32 v65, s70, v32
    v_lshlrev_b32 v66, 16, v33
    v_and_b32 v67, s70, v33
    v_lshlrev_b32 v68, 16, v34
    v_and_b32 v69, s70, v34
    v_lshlrev_b32 v70, 16, v35
    v_and_b32 v71, s70, v35
    v_lshlrev_b32 v72, 16, v36
    v_and_b32 v73, s70, v36
    v_lshlrev_b32 v74, 16, v37
    v_and_b32 v75, s70, v37
    v_lshlrev_b32 v76, 16, v38
    v_and_b32 v77, s70, v38
    v_lshlrev_b32 v78, 16, v39
    v_and_b32 v79, s70, v39
    v_add_f32 v6, v6, v7
    s_nop 1
    v_add_f32_dpp v6, v6, v6 quad_perm:[1,0,3,2] row_mask:0xf bank_mask:0xf
    s_nop 1
    v_add_f32_dpp v6, v6, v6 quad_perm:[2,3,0,1] row_mask:0xf bank_mask:0xf
    v_mov_b32 v7, v6
    s_nop 1
    v_permlane16_swap_b32 v6, v7
    v_add_f32 v6, v6, v7
    v_mov_b32 v7, v6
    s_nop 1
    v_permlane32_swap_b32 v6, v7
    v_add_f32 v6, v6, v7
    v_mul_f32 v6, 0x3acccccd, v6
    v_pk_add_f32 v[80:81], v[40:41], v[6:7] op_sel_hi:[1,0] neg_lo:[0,1] neg_hi:[0,1]
    v_pk_add_f32 v[82:83], v[42:43], v[6:7] op_sel_hi:[1,0] neg_lo:[0,1] neg_hi:[0,1]
    v_pk_add_f32 v[84:85], v[44:45], v[6:7] op_sel_hi:[1,0] neg_lo:[0,1] neg_hi:[0,1]
    v_pk_add_f32 v[86:87], v[46:47], v[6:7] op_sel_hi:[1,0] neg_lo:[0,1] neg_hi:[0,1]
    v_pk_add_f32 v[88:89], v[48:49], v[6:7] op_sel_hi:[1,0] neg_lo:[0,1] neg_hi:[0,1]
    v_pk_add_f32 v[90:91], v[50:51], v[6:7] op_sel_hi:[1,0] neg_lo:[0,1] neg_hi:[0,1]
    v_pk_add_f32 v[92:93], v[52:53], v[6:7] op_sel_hi:[1,0] neg_lo:[0,1] neg_hi:[0,1]
    v_pk_add_f32 v[94:95], v[54:55], v[6:7] op_sel_hi:[1,0] neg_lo:[0,1] neg_hi:[0,1]
    v_pk_add_f32 v[96:97], v[56:57], v[6:7] op_sel_hi:[1,0] neg_lo:[0,1] neg_hi:[0,1]
    v_pk_add_f32 v[98:99], v[58:59], v[6:7] op_sel_hi:[1,0] neg_lo:[0,1] neg_hi:[0,1]
    v_pk_add_f32 v[100:101], v[60:61], v[6:7] op_sel_hi:[1,0] neg_lo:[0,1] neg_hi:[0,1]
    v_pk_add_f32 v[102:103], v[62:63], v[6:7] op_sel_hi:[1,0] neg_lo:[0,1] neg_hi:[0,1]
    v_pk_add_f32 v[104:105], v[64:65], v[6:7] op_sel_hi:[1,0] neg_lo:[0,1] neg_hi:[0,1]
    v_pk_add_f32 v[106:107], v[66:67], v[6:7] op_sel_hi:[1,0] neg_lo:[0,1] neg_hi:[0,1]
    v_pk_add_f32 v[108:109], v[68:69], v[6:7] op_sel_hi:[1,0] neg_lo:[0,1] neg_hi:[0,1]
    v_pk_add_f32 v[110:111], v[70:71], v[6:7] op_sel_hi:[1,0] neg_lo:[0,1] neg_hi:[0,1]
    v_pk_add_f32 v[112:113], v[72:73], v[6:7] op_sel_hi:[1,0] neg_lo:[0,1] neg_hi:[0,1]
    v_pk_add_f32 v[114:115], v[74:75], v[6:7] op_sel_hi:[1,0] neg_lo:[0,1] neg_hi:[0,1]
    v_pk_add_f32 v[116:117], v[76:77], v[6:7] op_sel_hi:[1,0] neg_lo:[0,1] neg_hi:[0,1]
    v_pk_add_f32 v[118:119], v[78:79], v[6:7] op_sel_hi:[1,0] neg_lo:[0,1] neg_hi:[0,1]
    v_pk_mul_f32 v[10:11], v[80:81], v[80:81]
    v_pk_mul_f32 v[12:13], v[82:83], v[82:83]
    v_pk_fma_f32 v[10:11], v[84:85], v[84:85], v[10:11]
    v_pk_fma_f32 v[12:13], v[86:87], v[86:87], v[12:13]
    v_pk_fma_f32 v[10:11], v[88:89], v[88:89], v[10:11]
    v_pk_fma_f32 v[12:13], v[90:91], v[90:91], v[12:13]
    v_pk_fma_f32 v[10:11], v[92:93], v[92:93], v[10:11]
    v_pk_fma_f32 v[12:13], v[94:95], v[94:95], v[12:13]
    v_pk_fma_f32 v[10:11], v[96:97], v[96:97], v[10:11]
    v_pk_fma_f32 v[12:13], v[98:99], v[98:99], v[12:13]
    v_pk_fma_f32 v[10:11], v[100:101], v[100:101], v[10:11]
    v_pk_fma_f32 v[12:13], v[102:103], v[102:103], v[12:13]
    v_pk_fma_f32 v[10:11], v[104:105], v[104:105], v[10:11]
    v_pk_fma_f32 v[12:13], v[106:107], v[106:107], v[12:13]
    v_pk_fma_f32 v[10:11], v[108:109], v[108:109], v[10:11]
    v_pk_fma_f32 v[12:13], v[110:111], v[110:111], v[12:13]
    v_pk_fma_f32 v[10:11], v[112:113], v[112:113], v[10:11]
    v_pk_fma_f32 v[12:13], v[114:115], v[114:115], v[12:13]
    v_pk_fma_f32 v[10:11], v[116:117], v[116:117], v[10:11]
    v_pk_fma_f32 v[12:13], v[118:119], v[118:119], v[12:13]
    v_cvt_pk_bf16_f32 v6, v6, v6
    v_and_b32 v6, s70, v6
    v_add_f32 v10, v10, v11
    v_add_f32 v12, v12, v13
    v_add_f32 v8, v10, v12
    s_nop 1
    v_add_f32_dpp v8, v8, v8 quad_perm:[1,0,3,2] row_mask:0xf bank_mask:0xf
    s_nop 1
    v_add_f32_dpp v8, v8, v8 quad_perm:[2,3,0,1] row_mask:0xf bank_mask:0xf
    v_mov_b32 v9, v8
    s_nop 1
    v_permlane16_swap_b32 v8, v9
    v_add_f32 v8, v8, v9
    v_mov_b32 v9, v8
    s_nop 1
    v_permlane32_swap_b32 v8, v9
    v_add_f32 v8, v8, v9
    v_pk_add_f32 v[40:41], v[40:41], v[6:7] op_sel_hi:[1,0] neg_lo:[0,1] neg_hi:[0,1]
    v_pk_add_f32 v[42:43], v[42:43], v[6:7] op_sel_hi:[1,0] neg_lo:[0,1] neg_hi:[0,1]
    v_pk_add_f32 v[44:45], v[44:45], v[6:7] op_sel_hi:[1,0] neg_lo:[0,1] neg_hi:[0,1]
    v_pk_add_f32 v[46:47], v[46:47], v[6:7] op_sel_hi:[1,0] neg_lo:[0,1] neg_hi:[0,1]
    v_pk_add_f32 v[48:49], v[48:49], v[6:7] op_sel_hi:[1,0] neg_lo:[0,1] neg_hi:[0,1]
    v_pk_add_f32 v[50:51], v[50:51], v[6:7] op_sel_hi:[1,0] neg_lo:[0,1] neg_hi:[0,1]
    v_pk_add_f32 v[52:53], v[52:53], v[6:7] op_sel_hi:[1,0] neg_lo:[0,1] neg_hi:[0,1]
    v_pk_add_f32 v[54:55], v[54:55], v[6:7] op_sel_hi:[1,0] neg_lo:[0,1] neg_hi:[0,1]
    v_pk_add_f32 v[56:57], v[56:57], v[6:7] op_sel_hi:[1,0] neg_lo:[0,1] neg_hi:[0,1]
    v_pk_add_f32 v[58:59], v[58:59], v[6:7] op_sel_hi:[1,0] neg_lo:[0,1] neg_hi:[0,1]
    v_pk_add_f32 v[60:61], v[60:61], v[6:7] op_sel_hi:[1,0] neg_lo:[0,1] neg_hi:[0,1]
    v_pk_add_f32 v[62:63], v[62:63], v[6:7] op_sel_hi:[1,0] neg_lo:[0,1] neg_hi:[0,1]
    v_pk_add_f32 v[64:65], v[64:65], v[6:7] op_sel_hi:[1,0] neg_lo:[0,1] neg_hi:[0,1]
    v_pk_add_f32 v[66:67], v[66:67], v[6:7] op_sel_hi:[1,0] neg_lo:[0,1] neg_hi:[0,1]
    v_pk_add_f32 v[68:69], v[68:69], v[6:7] op_sel_hi:[1,0] neg_lo:[0,1] neg_hi:[0,1]
    v_pk_add_f32 v[70:71], v[70:71], v[6:7] op_sel_hi:[1,0] neg_lo:[0,1] neg_hi:[0,1]
    v_pk_add_f32 v[72:73], v[72:73], v[6:7] op_sel_hi:[1,0] neg_lo:[0,1] neg_hi:[0,1]
    v_pk_add_f32 v[74:75], v[74:75], v[6:7] op_sel_hi:[1,0] neg_lo:[0,1] neg_hi:[0,1]
    v_pk_add_f32 v[76:77], v[76:77], v[6:7] op_sel_hi:[1,0] neg_lo:[0,1] neg_hi:[0,1]
    v_pk_add_f32 v[78:79], v[78:79], v[6:7] op_sel_hi:[1,0] neg_lo:[0,1] neg_hi:[0,1]
    v_mul_f32 v8, 0x3acccccd, v8
    v_cvt_pk_bf16_f32 v8, v8, v8
    v_and_b32 v8, s70, v8
    v_add_f32 v8, 0x3727c5ac, v8
    v_cvt_pk_bf16_f32 v8, v8, v8
    v_and_b32 v8, s70, v8
    v_sqrt_f32 v8, v8
    v_cvt_pk_bf16_f32 v20, v40, v41
    v_cvt_pk_bf16_f32 v21, v42, v43
    v_cvt_pk_bf16_f32 v22, v44, v45
    v_cvt_pk_bf16_f32 v23, v46, v47
    v_cvt_pk_bf16_f32 v24, v48, v49
    v_cvt_pk_bf16_f32 v25, v50, v51
    v_cvt_pk_bf16_f32 v26, v52, v53
    v_cvt_pk_bf16_f32 v27, v54, v55
    v_cvt_pk_bf16_f32 v28, v56, v57
    v_cvt_pk_bf16_f32 v29, v58, v59
    v_cvt_pk_bf16_f32 v30, v60, v61
    v_cvt_pk_bf16_f32 v31, v62, v63
    v_cvt_pk_bf16_f32 v32, v64, v65
    v_cvt_pk_bf16_f32 v33, v66, v67
    v_cvt_pk_bf16_f32 v34, v68, v69
    v_cvt_pk_bf16_f32 v35, v70, v71
    v_cvt_pk_bf16_f32 v36, v72, v73
    v_cvt_pk_bf16_f32 v37, v74, v75
    v_cvt_pk_bf16_f32 v38, v76, v77
    v_cvt_pk_bf16_f32 v39, v78, v79
    v_cvt_pk_bf16_f32 v8, v8, v8
    v_and_b32 v8, s70, v8
    v_rcp_f32 v8, v8
    v_lshlrev_b32 v40, 16, v20
    v_and_b32 v41, s70, v20
    v_lshlrev_b32 v42, 16, v21
    v_and_b32 v43, s70, v21
    v_lshlrev_b32 v44, 16, v22
    v_and_b32 v45, s70, v22
    v_lshlrev_b32 v46, 16, v23
    v_and_b32 v47, s70, v23
    v_lshlrev_b32 v48, 16, v24
    v_and_b32 v49, s70, v24
    v_lshlrev_b32 v50, 16, v25
    v_and_b32 v51, s70, v25
    v_lshlrev_b32 v52, 16, v26
    v_and_b32 v53, s70, v26
    v_lshlrev_b32 v54, 16, v27
    v_and_b32 v55, s70, v27
    v_lshlrev_b32 v56, 16, v28
    v_and_b32 v57, s70, v28
    v_lshlrev_b32 v58, 16, v29
    v_and_b32 v59, s70, v29
    v_lshlrev_b32 v60, 16, v30
    v_and_b32 v61, s70, v30
    v_lshlrev_b32 v62, 16, v31
    v_and_b32 v63, s70, v31
    v_lshlrev_b32 v64, 16, v32
    v_and_b32 v65, s70, v32
    v_lshlrev_b32 v66, 16, v33
    v_and_b32 v67, s70, v33
    v_lshlrev_b32 v68, 16, v34
    v_and_b32 v69, s70, v34
    v_lshlrev_b32 v70, 16, v35
    v_and_b32 v71, s70, v35
    v_lshlrev_b32 v72, 16, v36
    v_and_b32 v73, s70, v36
    v_lshlrev_b32 v74, 16, v37
    v_and_b32 v75, s70, v37
    v_lshlrev_b32 v76, 16, v38
    v_and_b32 v77, s70, v38
    v_lshlrev_b32 v78, 16, v39
    v_and_b32 v79, s70, v39
    v_pk_mul_f32 v[40:41], v[40:41], v[8:9] op_sel_hi:[1,0]
    v_pk_mul_f32 v[42:43], v[42:43], v[8:9] op_sel_hi:[1,0]
    v_pk_mul_f32 v[44:45], v[44:45], v[8:9] op_sel_hi:[1,0]
    v_pk_mul_f32 v[46:47], v[46:47], v[8:9] op_sel_hi:[1,0]
    v_pk_mul_f32 v[48:49], v[48:49], v[8:9] op_sel_hi:[1,0]
    v_pk_mul_f32 v[50:51], v[50:51], v[8:9] op_sel_hi:[1,0]
    v_pk_mul_f32 v[52:53], v[52:53], v[8:9] op_sel_hi:[1,0]
    v_pk_mul_f32 v[54:55], v[54:55], v[8:9] op_sel_hi:[1,0]
    v_pk_mul_f32 v[56:57], v[56:57], v[8:9] op_sel_hi:[1,0]
    v_pk_mul_f32 v[58:59], v[58:59], v[8:9] op_sel_hi:[1,0]
    v_pk_mul_f32 v[60:61], v[60:61], v[8:9] op_sel_hi:[1,0]
    v_pk_mul_f32 v[62:63], v[62:63], v[8:9] op_sel_hi:[1,0]
    v_pk_mul_f32 v[64:65], v[64:65], v[8:9] op_sel_hi:[1,0]
    v_pk_mul_f32 v[66:67], v[66:67], v[8:9] op_sel_hi:[1,0]
    v_pk_mul_f32 v[68:69], v[68:69], v[8:9] op_sel_hi:[1,0]
    v_pk_mul_f32 v[70:71], v[70:71], v[8:9] op_sel_hi:[1,0]
    v_pk_mul_f32 v[72:73], v[72:73], v[8:9] op_sel_hi:[1,0]
    v_pk_mul_f32 v[74:75], v[74:75], v[8:9] op_sel_hi:[1,0]
    v_pk_mul_f32 v[76:77], v[76:77], v[8:9] op_sel_hi:[1,0]
    v_pk_mul_f32 v[78:79], v[78:79], v[8:9] op_sel_hi:[1,0]
    v_cvt_pk_bf16_f32 v20, v40, v41
    v_cvt_pk_bf16_f32 v21, v42, v43
    v_cvt_pk_bf16_f32 v22, v44, v45
    v_cvt_pk_bf16_f32 v23, v46, v47
    v_cvt_pk_bf16_f32 v24, v48, v49
    v_cvt_pk_bf16_f32 v25, v50, v51
    v_cvt_pk_bf16_f32 v26, v52, v53
    v_cvt_pk_bf16_f32 v27, v54, v55
    v_cvt_pk_bf16_f32 v28, v56, v57
    v_cvt_pk_bf16_f32 v29, v58, v59
    v_cvt_pk_bf16_f32 v30, v60, v61
    v_cvt_pk_bf16_f32 v31, v62, v63
    v_cvt_pk_bf16_f32 v32, v64, v65
    v_cvt_pk_bf16_f32 v33, v66, v67
    v_cvt_pk_bf16_f32 v34, v68, v69
    v_cvt_pk_bf16_f32 v35, v70, v71
    v_cvt_pk_bf16_f32 v36, v72, v73
    v_cvt_pk_bf16_f32 v37, v74, v75
    v_cvt_pk_bf16_f32 v38, v76, v77
    v_cvt_pk_bf16_f32 v39, v78, v79
    v_add_u32 v3, 99840, v3
    v_mov_b32 v6, 120120
    v_mov_b32 v7, 1
    ds_write_b128 v3, v[20:23] offset:0
    ds_write_b128 v3, v[24:27] offset:256
    ds_write_b128 v3, v[28:31] offset:512
    ds_write_b128 v3, v[32:35] offset:768
    ds_write_b128 v3, v[36:39] offset:1024
    ds_write_b32 v6, v7
L_xw:
    s_add_u32 s72, s72, 99840
    v_add_u32 v4, s72, v4
    v_mov_b32 v6, 120120
L_xv:
    ds_read_b32 v7, v6 offset:0
    s_waitcnt lgkmcnt(0)
    v_cmp_gt_u32 vcc, 1, v7
    s_cbranch_vccz L_xvd
    s_sleep 1
    s_branch L_xv
L_xvd:
    ds_read_b64 v[10:11], v4 offset:0
    ds_read_b64 v[12:13], v4 offset:32
    ds_read_b64 v[14:15], v4 offset:64
    ds_read_b64 v[16:17], v4 offset:96
    ds_read_b64 v[18:19], v4 offset:128
    v_and_b32 v1, 3, v0
    v_lshlrev_b32 v5, 7, v2
    v_lshl_add_u32 v5, v1, 3, v5
    s_mul_i32 s74, s3, 24576
    v_add_u32 v5, s74, v5
    v_mov_b32 v9, 0xff
    v_lshlrev_b32 v8, 4, v0
L_np0:
    v_mov_b32 v6, 112384
    ds_read_b32 v6, v6 offset:4
    s_waitcnt lgkmcnt(0)
    v_readfirstlane_b32 s64, v6
    s_nop 1
    s_cmp_eq_u32 s64, 0
    s_cbranch_scc1 L_np0
    s_lshr_b32 s65, s64, 8
    s_lshr_b32 s66, s64, 16
    s_lshr_b32 s67, s64, 24
    s_waitcnt vmcnt(0)
    ds_read_b64_tr_b16 v[28:29], v5 offset:8192
    ds_read_b64_tr_b16 v[40:41], v5 offset:8224
    ds_read_b64_tr_b16 v[52:53], v5 offset:8256
    ds_read_b64_tr_b16 v[64:65], v5 offset:8288
    ds_read_b64_tr_b16 v[20:21], v5 offset:0
    ds_read_b64_tr_b16 v[22:23], v5 offset:2048
    ds_read_b64_tr_b16 v[32:33], v5 offset:32
    ds_read_b64_tr_b16 v[34:35], v5 offset:2080
    ds_read_b64_tr_b16 v[44:45], v5 offset:64
    ds_read_b64_tr_b16 v[46:47], v5 offset:2112
    ds_read_b64_tr_b16 v[56:57], v5 offset:96
    ds_read_b64_tr_b16 v[58:59], v5 offset:2144
    ds_read_b64_tr_b16 v[24:25], v5 offset:4096
    ds_read_b64_tr_b16 v[26:27], v5 offset:6144
    ds_read_b64_tr_b16 v[36:37], v5 offset:4128
    ds_read_b64_tr_b16 v[38:39], v5 offset:6176
    ds_read_b64_tr_b16 v[48:49], v5 offset:4160
    ds_read_b64_tr_b16 v[50:51], v5 offset:6208
    ds_read_b64_tr_b16 v[60:61], v5 offset:4192
    ds_read_b64_tr_b16 v[62:63], v5 offset:6240
    s_lshl_b32 s73, s80, 10
    s_add_u32 s73, s73, s81
    s_lshl_b32 s74, s3, 10
    v_add_u32 v7, 112448, v8
    v_add_u32 v6, s74, v7
    s_add_u32 s74, s74, 112448
    v_and_b32 v6, 0xf0, v8
    v_lshrrev_b32 v3, 4, v0
    v_lshl_add_u32 v6, v3, 2, v6
    v_add_u32 v6, s74, v6
    v_mov_b32 v3, 120124
    v_mov_b32 v4, 1
    s_waitcnt lgkmcnt(15)
    v_mfma_f32_16x16x16_bf16 v[68:71], v[18:19], v[28:29], 0
    v_mfma_f32_16x16x16_bf16 v[72:75], v[18:19], v[40:41], 0
    v_mfma_f32_16x16x16_bf16 v[76:79], v[18:19], v[52:53], 0
    v_mfma_f32_16x16x16_bf16 v[80:83], v[18:19], v[64:65], 0
    s_waitcnt lgkmcnt(8)
    s_nop 1
    v_mfma_f32_16x16x32_bf16 v[68:71], v[10:13], v[20:23], v[68:71]
    v_mfma_f32_16x16x32_bf16 v[72:75], v[10:13], v[32:35], v[72:75]
    v_mfma_f32_16x16x32_bf16 v[76:79], v[10:13], v[44:47], v[76:79]
    v_mfma_f32_16x16x32_bf16 v[80:83], v[10:13], v[56:59], v[80:83]
    s_waitcnt lgkmcnt(0)
    v_mfma_f32_16x16x32_bf16 v[68:71], v[14:17], v[24:27], v[68:71]
    v_mfma_f32_16x16x32_bf16 v[72:75], v[14:17], v[36:39], v[72:75]
    v_mfma_f32_16x16x32_bf16 v[76:79], v[14:17], v[48:51], v[76:79]
    v_mfma_f32_16x16x32_bf16 v[80:83], v[14:17], v[60:63], v[80:83]
    s_nop 5
    ds_write2_b32 v6, v68, v72 offset0:0 offset1:64
    s_nop 0
    ds_write2_b32 v6, v76, v80 offset0:128 offset1:192
    s_mov_b64 exec, 1
    ds_add_rtn_u32 v4, v3, v4
    s_mov_b64 exec, -1
    s_waitcnt lgkmcnt(0)
    v_readfirstlane_b32 s72, v4
    s_nop 1
    s_cmp_lg_u32 s72, 3
    s_cbranch_scc1 L_qc
    ds_read_b128 v[20:23], v7 offset:0
    ds_read_b128 v[24:27], v7 offset:1024
    ds_read_b128 v[28:31], v7 offset:2048
    ds_read_b128 v[32:35], v7 offset:3072
    s_waitcnt lgkmcnt(2)
    v_pk_add_f32 v[20:21], v[20:21], v[24:25]
    v_pk_add_f32 v[22:23], v[22:23], v[26:27]
    s_waitcnt lgkmcnt(0)
    v_pk_add_f32 v[28:29], v[28:29], v[32:33]
    v_pk_add_f32 v[30:31], v[30:31], v[34:35]
    v_pk_add_f32 v[36:37], v[20:21], v[28:29]
    v_pk_add_f32 v[38:39], v[22:23], v[30:31]
    v_bfi_b32 v36, v9, s64, v36
    v_bfi_b32 v37, v9, s65, v37
    v_bfi_b32 v38, v9, s66, v38
    v_bfi_b32 v39, v9, s67, v39
    buffer_store_dwordx4 v[36:39], v8, s[16:19], s73 offen sc1
    s_branch L_qc
L_nop:
    v_mov_b32 v9, 0xff
    v_lshlrev_b32 v8, 4, v0
L_np1:
    v_mov_b32 v6, 112384
    ds_read_b32 v6, v6 offset:4
    s_waitcnt lgkmcnt(0)
    v_readfirstlane_b32 s64, v6
    s_nop 1
    s_cmp_eq_u32 s64, 0
    s_cbranch_scc1 L_np1
    s_lshr_b32 s65, s64, 8
    s_lshr_b32 s66, s64, 16
    s_lshr_b32 s67, s64, 24
    s_sleep 70
L_qc:
    v_mov_b32 v3, 112384
    v_mov_b32 v4, 1
    s_cmp_eq_u32 s3, 3
    s_cbranch_scc1 L_role
    s_lshl_b32 s73, s3, 11
    s_add_u32 s73, s73, s81
    s_sleep 40
L_qg:
    buffer_load_dwordx4 v[20:23], v8, s[16:19], s73 offen offset:0 sc1
    buffer_load_dwordx4 v[24:27], v8, s[16:19], s73 offen offset:1024 sc1
    s_waitcnt vmcnt(0)
    v_xor_b32 v10, s64, v20
    v_xor_b32 v11, s65, v21
    v_bitop3_b32 v10, v10, v22, s66 bitop3:0xf6
    v_bitop3_b32 v11, v11, v23, s67 bitop3:0xf6
    v_bitop3_b32 v10, v10, v24, s64 bitop3:0xf6
    v_bitop3_b32 v11, v11, v25, s65 bitop3:0xf6
    v_bitop3_b32 v10, v10, v26, s66 bitop3:0xf6
    v_bitop3_b32 v11, v11, v27, s67 bitop3:0xf6
    v_bitop3_b32 v10, v10, v11, v9 bitop3:0xa8
    v_cmp_ne_u32 vcc, 0, v10
    s_cbranch_vccz L_qgd
    s_sub_u32 s68, s68, 1
    s_cbranch_scc1 L_qgd
    s_branch L_qg
L_qgd:
    s_mov_b32 s68, 16384
    s_mov_b32 s75, 0x80
    v_bfi_b32 v20, v9, s75, v20
    v_bfi_b32 v21, v9, s75, v21
    v_bfi_b32 v22, v9, s75, v22
    v_bfi_b32 v23, v9, s75, v23
    v_bfi_b32 v24, v9, s75, v24
    v_bfi_b32 v25, v9, s75, v25
    v_bfi_b32 v26, v9, s75, v26
    v_bfi_b32 v27, v9, s75, v27
    v_add_f32 v20, v20, v24
    v_add_f32 v21, v21, v25
    v_add_f32 v22, v22, v26
    v_add_f32 v23, v23, v27
    v_cvt_pk_bf16_f32 v20, v20, v21
    v_cvt_pk_bf16_f32 v22, v22, v23
    s_lshl_b32 s74, s3, 7
    s_add_u32 s74, s74, 98304
    v_lshl_add_u32 v5, v0, 1, s74
    ds_write_b16 v5, v20
    ds_write_b16_d16_hi v5, v20 offset:384
    ds_write_b16 v5, v22 offset:768
    ds_write_b16_d16_hi v5, v22 offset:1152
    s_mov_b64 exec, 1
    ds_add_u32 v3, v4 offset:0
    s_mov_b64 exec, -1
L_role:
    s_lshl_b32 s72, s5, 2
    s_add_u32 s72, s72, s4
    s_and_b32 s72, s72, 31
    s_mov_b32 s57, 0
    s_mul_i32 s74, s3, 24576
    v_lshrrev_b32 v5, 1, v0
    v_and_b32 v5, 16, v5
    v_lshrrev_b32 v6, 2, v0
    v_and_b32 v6, 5, v6
    v_and_b32 v7, 8, v0
    v_or3_b32 v6, v5, v6, v7
    v_lshrrev_b32 v5, 4, v0
    v_and_b32 v7, 3, v0
    v_and_b32 v63, 15, v0
    v_lshlrev_b32 v63, 2, v63
    s_cmp_eq_u32 s5, 0
    s_cbranch_scc1 L_ffn
    s_mov_b32 s75, s5
    s_cmp_lt_u32 s72, 10
    s_cbranch_scc1 L_s2
    s_cmp_lg_u32 s5, 4
    s_cbranch_scc1 L_idle
    s_mov_b32 s75, 0
    s_xor_b32 s72, s72, 16
    s_cmp_ge_u32 s72, 10
    s_cbranch_scc1 L_idle
L_s2:
    s_mul_i32 s59, s75, 2560
    s_lshl_b32 s73, s72, 8
    s_add_u32 s59, s59, s73
    s_add_u32 s59, s59, 2097152
    s_lshl_b32 s75, s75, 2
    s_add_u32 s75, s75, s3
    s_lshl_b32 s58, s75, 12
    s_add_u32 s58, s58, 1179648
    s_mul_i32 s73, s75, 245760
    s_lshl_b32 s72, s72, 7
    s_add_u32 s73, s73, s72
    v_lshrrev_b32 v2, 3, v0
    v_mul_u32_u24 v2, 1280, v2
    v_and_b32 v1, 7, v0
    v_lshl_add_u32 v2, v1, 4, v2
    s_add_u32 s75, s74, 24576
L_dwo:
    s_mov_b32 m0, s74
    s_add_u32 s74, s74, 1024
    buffer_load_dwordx4 v2, s[32:35], s73 offen nt lds
    s_add_u32 s73, s73, 10240
    s_waitcnt vmcnt(1)
    s_cmp_lt_u32 s74, s75
    s_cbranch_scc1 L_dwo
    v_lshlrev_b32 v10, 7, v6
    v_lshl_add_u32 v10, v7, 3, v10
    s_mul_i32 s72, s3, 24576
    v_add_u32 v10, s72, v10
    s_waitcnt vmcnt(0)
    ds_read_b64_tr_b16 v[128:129], v10 offset:0
    ds_read_b64_tr_b16 v[130:131], v10 offset:256
    ds_read_b64_tr_b16 v[132:133], v10 offset:4096
    ds_read_b64_tr_b16 v[134:135], v10 offset:4352
    ds_read_b64_tr_b16 v[136:137], v10 offset:8192
    ds_read_b64_tr_b16 v[138:139], v10 offset:8448
    ds_read_b64_tr_b16 v[140:141], v10 offset:12288
    ds_read_b64_tr_b16 v[142:143], v10 offset:12544
    ds_read_b64_tr_b16 v[144:145], v10 offset:16384
    ds_read_b64_tr_b16 v[146:147], v10 offset:16640
    ds_read_b64_tr_b16 v[148:149], v10 offset:20480
    ds_read_b64_tr_b16 v[150:151], v10 offset:20736
    s_waitcnt lgkmcnt(0)
    ds_read_b64_tr_b16 v[152:153], v10 offset:32
    ds_read_b64_tr_b16 v[154:155], v10 offset:288
    ds_read_b64_tr_b16 v[156:157], v10 offset:4128
    ds_read_b64_tr_b16 v[158:159], v10 offset:4384
    ds_read_b64_tr_b16 v[160:161], v10 offset:8224
    ds_read_b64_tr_b16 v[162:163], v10 offset:8480
    ds_read_b64_tr_b16 v[164:165], v10 offset:12320
    ds_read_b64_tr_b16 v[166:167], v10 offset:12576
    ds_read_b64_tr_b16 v[168:169], v10 offset:16416
    ds_read_b64_tr_b16 v[170:171], v10 offset:16672
    ds_read_b64_tr_b16 v[172:173], v10 offset:20512
    ds_read_b64_tr_b16 v[174:175], v10 offset:20768
    s_waitcnt lgkmcnt(0)
    ds_read_b64_tr_b16 v[176:177], v10 offset:64
    ds_read_b64_tr_b16 v[178:179], v10 offset:320
    ds_read_b64_tr_b16 v[180:181], v10 offset:4160
    ds_read_b64_tr_b16 v[182:183], v10 offset:4416
    ds_read_b64_tr_b16 v[184:185], v10 offset:8256
    ds_read_b64_tr_b16 v[186:187], v10 offset:8512
    ds_read_b64_tr_b16 v[188:189], v10 offset:12352
    ds_read_b64_tr_b16 v[190:191], v10 offset:12608
    ds_read_b64_tr_b16 v[192:193], v10 offset:16448
    ds_read_b64_tr_b16 v[194:195], v10 offset:16704
    ds_read_b64_tr_b16 v[196:197], v10 offset:20544
    ds_read_b64_tr_b16 v[198:199], v10 offset:20800
    s_waitcnt lgkmcnt(0)
    ds_read_b64_tr_b16 v[200:201], v10 offset:96
    ds_read_b64_tr_b16 v[202:203], v10 offset:352
    ds_read_b64_tr_b16 v[204:205], v10 offset:4192
    ds_read_b64_tr_b16 v[206:207], v10 offset:4448
    ds_read_b64_tr_b16 v[208:209], v10 offset:8288
    ds_read_b64_tr_b16 v[210:211], v10 offset:8544
    ds_read_b64_tr_b16 v[212:213], v10 offset:12384
    ds_read_b64_tr_b16 v[214:215], v10 offset:12640
    ds_read_b64_tr_b16 v[216:217], v10 offset:16480
    ds_read_b64_tr_b16 v[218:219], v10 offset:16736
    ds_read_b64_tr_b16 v[220:221], v10 offset:20576
    ds_read_b64_tr_b16 v[222:223], v10 offset:20832
    s_waitcnt lgkmcnt(0)
    v_lshlrev_b32 v8, 4, v0
    v_and_b32 v10, 31, v0
    v_lshrrev_b32 v11, 5, v0
    v_lshl_add_u32 v10, v10, 1, v11
    s_mul_i32 s72, s3, 384
    s_add_u32 s72, s72, 112448
    v_lshl_add_u32 v2, v10, 2, s72
    v_lshl_add_u32 v7, v10, 1, s72
    v_and_b32 v10, 1, v0
    v_lshlrev_b32 v11, 4, v10
    v_lshrrev_b32 v224, v11, s64
    v_mov_b32 v225, 0xffff
    v_mov_b32 v226, 0x07060302
    v_mov_b32 v227, 0x03020706
    v_cmp_eq_u32 vcc, 1, v10
    s_nop 1
    v_cndmask_b32 v226, v226, v227, vcc
    v_bfe_u32 v1, v0, 1, 2
    v_lshlrev_b32 v1, 9, v1
    v_add_u32 v1, v1, v11
    v_and_b32 v10, 1, v0
    v_lshl_add_u32 v10, v5, 1, v10
    v_lshlrev_b32 v6, 4, v10
    v_add_u32 v6, 112448, v6
    s_sub_u32 s72, s72, 112448
    v_add_u32 v6, s72, v6
    v_and_b32 v230, 1, v0
    v_mul_u32_u24 v230, 0xaaaa, v230
    v_add_u32 v230, 0x4444, v230
    v_lshl_add_u32 v230, v230, 16, v230
    v_lshlrev_b32 v5, 2, v0
    v_add_u32 v231, 114496, v5
    s_lshl_b32 s72, s3, 8
    v_add_u32 v232, s72, v231
    v_lshlrev_b32 v10, 3, v0
    v_lshrrev_b32 v227, v10, s64
    s_branch L_pre
L_s2b:
    s_cmp_eq_u32 s56, 2
    s_cbranch_scc1 L_pre2
L_s2bc:
    v_mov_b32 v80, 0
    v_mov_b32 v81, 0
    v_mov_b32 v82, 0
    v_mov_b32 v83, 0
    v_mov_b32 v84, 0
    v_mov_b32 v85, 0
    v_mov_b32 v86, 0
    v_mov_b32 v87, 0
    v_mov_b32 v88, 0
    v_mov_b32 v89, 0
    v_mov_b32 v90, 0
    v_mov_b32 v91, 0
    v_mov_b32 v92, 0
    v_mov_b32 v93, 0
    v_mov_b32 v94, 0
    v_mov_b32 v95, 0
    s_cmp_ge_u32 s56, 2
    s_cselect_b32 s72, 2048, 0
    s_add_u32 s72, s72, s58
    s_cmp_lg_u32 s56, 3
    s_cbranch_scc1 L_s2wd
L_s2w:
    ds_read_b32 v10, v3 offset:16
    s_waitcnt lgkmcnt(0)
    v_cmp_gt_u32 vcc, 4, v10
    s_cbranch_vccz L_s2wd
    s_sleep 2
    s_branch L_s2w
L_s2wd:
    s_bitcmp0_b32 7, s56
    s_cbranch_scc1 L_og
L_op:
    buffer_load_dword v20, v1, s[16:19], s58 offen offset:12 sc1
    buffer_load_dword v21, v1, s[16:19], s72 offen offset:12 sc1
    s_waitcnt vmcnt(0)
    v_xor_b32 v10, v224, v20
    v_xor_b32 v11, v224, v21
    v_bitop3_b32 v10, v10, v11, v225 bitop3:0xa8
    v_cmp_ne_u32 vcc, 0, v10
    s_cbranch_vccz L_opd
    s_sub_u32 s68, s68, 1
    s_cbranch_scc1 L_opd
    s_cmp_eq_u32 s56, 3
    s_cbranch_scc1 L_op
    s_sleep 32
    s_cmp_lg_u32 s56, 0
    s_cbranch_scc1 L_op
    s_sleep 100
    s_branch L_op
L_opd:
    s_mov_b32 s68, 16384
L_og:
    s_mov_b64 s[8:9], -1
    s_mov_b64 s[10:11], -1
    s_mov_b64 s[12:13], -1
    s_mov_b64 s[14:15], -1
L_ogl:
    s_wqm_b64 exec, s[8:9]
    buffer_load_dwordx4 v[20:23], v8, s[16:19], s58 offen offset:0 sc1
    s_wqm_b64 exec, s[10:11]
    buffer_load_dwordx4 v[24:27], v8, s[16:19], s58 offen offset:1024 sc1
    s_wqm_b64 exec, s[12:13]
    buffer_load_dwordx4 v[28:31], v8, s[16:19], s72 offen offset:0 sc1
    s_wqm_b64 exec, s[14:15]
    buffer_load_dwordx4 v[32:35], v8, s[16:19], s72 offen offset:1024 sc1
    s_mov_b64 exec, -1
L_ogw:
    s_waitcnt vmcnt(0)
    v_xor_b32 v10, v224, v23
    v_xor_b32 v11, v224, v27
    v_xor_b32 v12, v224, v31
    v_xor_b32 v13, v224, v35
    v_and_b32 v10, v225, v10
    v_and_b32 v11, v225, v11
    v_and_b32 v12, v225, v12
    v_and_b32 v13, v225, v13
    v_cmp_ne_u32 s[8:9], 0, v10
    v_cmp_ne_u32 s[10:11], 0, v11
    v_cmp_ne_u32 s[12:13], 0, v12
    v_cmp_ne_u32 s[14:15], 0, v13
    s_nop 1
    s_or_b64 vcc, s[8:9], s[10:11]
    s_or_b64 vcc, vcc, s[12:13]
    s_or_b64 vcc, vcc, s[14:15]
    s_cbranch_scc0 L_ogd
    s_sub_u32 s68, s68, 1
    s_cbranch_scc1 L_ogd
    s_cmp_eq_u32 s56, 3
    s_cbranch_scc1 L_ogl
    s_sleep 32
    s_branch L_ogl
L_ogd:
    s_mov_b32 s68, 16384
    v_mov_b32_dpp v12, v23 quad_perm:[1,0,3,2] row_mask:0xf bank_mask:0xf
    v_mov_b32_dpp v13, v27 quad_perm:[1,0,3,2] row_mask:0xf bank_mask:0xf
    v_mov_b32_dpp v14, v31 quad_perm:[1,0,3,2] row_mask:0xf bank_mask:0xf
    v_mov_b32_dpp v15, v35 quad_perm:[1,0,3,2] row_mask:0xf bank_mask:0xf
    v_perm_b32 v60, v12, v23, v226
    v_perm_b32 v62, v13, v27, v226
    v_perm_b32 v64, v14, v31, v226
    v_perm_b32 v66, v15, v35, v226
    v_max3_f32 v10, v60, v62, v64
    v_max_f32 v10, v10, v66
    v_mov_b32 v11, v10
    v_lshlrev_b32 v36, 16, v20
    v_and_b32 v37, s70, v20
    v_lshlrev_b32 v38, 16, v21
    v_and_b32 v39, s70, v21
    v_lshlrev_b32 v40, 16, v22
    v_and_b32 v41, s70, v22
    v_permlane32_swap_b32 v10, v11
    v_max_f32 v10, v10, v11
    v_sub_f32 v60, v60, v10
    v_sub_f32 v62, v62, v10
    v_sub_f32 v64, v64, v10
    v_sub_f32 v66, v66, v10
    v_exp_f32 v60, v60
    v_exp_f32 v62, v62
    v_exp_f32 v64, v64
    v_exp_f32 v66, v66
    v_lshlrev_b32 v42, 16, v24
    v_and_b32 v43, s70, v24
    v_lshlrev_b32 v44, 16, v25
    v_and_b32 v45, s70, v25
    v_lshlrev_b32 v46, 16, v26
    v_and_b32 v47, s70, v26
    v_add_f32 v10, v60, v62
    v_add_f32 v11, v64, v66
    v_add_f32 v10, v10, v11
    v_mov_b32 v11, v10
    v_lshlrev_b32 v48, 16, v28
    v_and_b32 v49, s70, v28
    v_lshlrev_b32 v50, 16, v29
    v_and_b32 v51, s70, v29
    v_lshlrev_b32 v52, 16, v30
    v_and_b32 v53, s70, v30
    v_permlane32_swap_b32 v10, v11
    v_add_f32 v10, v10, v11
    v_rcp_f32 v10, v10
    v_lshlrev_b32 v54, 16, v32
    v_and_b32 v55, s70, v32
    v_lshlrev_b32 v56, 16, v33
    v_and_b32 v57, s70, v33
    v_lshlrev_b32 v58, 16, v34
    v_and_b32 v59, s70, v34
    v_pk_mul_f32 v[12:13], v[36:37], v[60:61] op_sel_hi:[1,0]
    v_pk_mul_f32 v[14:15], v[38:39], v[60:61] op_sel_hi:[1,0]
    v_pk_mul_f32 v[16:17], v[40:41], v[60:61] op_sel_hi:[1,0]
    v_pk_fma_f32 v[12:13], v[42:43], v[62:63], v[12:13] op_sel_hi:[1,0,1]
    v_pk_fma_f32 v[14:15], v[44:45], v[62:63], v[14:15] op_sel_hi:[1,0,1]
    v_pk_fma_f32 v[16:17], v[46:47], v[62:63], v[16:17] op_sel_hi:[1,0,1]
    v_pk_fma_f32 v[12:13], v[48:49], v[64:65], v[12:13] op_sel_hi:[1,0,1]
    v_pk_fma_f32 v[14:15], v[50:51], v[64:65], v[14:15] op_sel_hi:[1,0,1]
    v_pk_fma_f32 v[16:17], v[52:53], v[64:65], v[16:17] op_sel_hi:[1,0,1]
    v_pk_fma_f32 v[12:13], v[54:55], v[66:67], v[12:13] op_sel_hi:[1,0,1]
    v_pk_fma_f32 v[14:15], v[56:57], v[66:67], v[14:15] op_sel_hi:[1,0,1]
    v_pk_fma_f32 v[16:17], v[58:59], v[66:67], v[16:17] op_sel_hi:[1,0,1]
    s_nop 0
    v_permlane32_swap_b32 v12, v14
    v_permlane32_swap_b32 v13, v15
    v_permlane32_swap_b32 v16, v17
    v_add_f32 v12, v12, v14
    v_add_f32 v13, v13, v15
    v_add_f32 v16, v16, v17
    v_mul_f32 v12, v10, v12
    v_mul_f32 v13, v10, v13
    v_mul_f32 v16, v10, v16
    v_cvt_pk_bf16_f32 v12, v12, v13
    v_cvt_pk_bf16_f32 v16, v16, v16
    ds_write_b32 v2, v12
    ds_write_b16 v7, v16 offset:256
    ds_read_b128 v[32:35], v6 offset:0
    ds_read_b128 v[36:39], v6 offset:128
    ds_read_b128 v[40:43], v6 offset:256
    s_waitcnt lgkmcnt(2)
    v_smfmac_f32_16x16x64_bf16 v[80:83], v[32:35], v[128:135], v230
    s_waitcnt lgkmcnt(1)
    v_smfmac_f32_16x16x64_bf16 v[80:83], v[36:39], v[136:143], v230
    s_waitcnt lgkmcnt(0)
    v_smfmac_f32_16x16x64_bf16 v[80:83], v[40:43], v[144:151], v230
    v_smfmac_f32_16x16x64_bf16 v[84:87], v[32:35], v[152:159], v230
    v_smfmac_f32_16x16x64_bf16 v[84:87], v[36:39], v[160:167], v230
    v_smfmac_f32_16x16x64_bf16 v[84:87], v[40:43], v[168:175], v230
    v_smfmac_f32_16x16x64_bf16 v[88:91], v[32:35], v[176:183], v230
    v_smfmac_f32_16x16x64_bf16 v[88:91], v[36:39], v[184:191], v230
    v_smfmac_f32_16x16x64_bf16 v[88:91], v[40:43], v[192:199], v230
    v_smfmac_f32_16x16x64_bf16 v[92:95], v[32:35], v[200:207], v230
    v_smfmac_f32_16x16x64_bf16 v[92:95], v[36:39], v[208:215], v230
    v_smfmac_f32_16x16x64_bf16 v[92:95], v[40:43], v[216:223], v230
    v_add_f32_dpp v12, v80, v81 quad_perm:[0,1,2,3] row_mask:0x1 bank_mask:0xf
    s_nop 1
    v_add_f32_dpp v12, v84, v85 quad_perm:[0,1,2,3] row_mask:0x2 bank_mask:0xf
    s_nop 1
    v_add_f32_dpp v12, v88, v89 quad_perm:[0,1,2,3] row_mask:0x4 bank_mask:0xf
    s_nop 1
    v_add_f32_dpp v12, v92, v93 quad_perm:[0,1,2,3] row_mask:0x8 bank_mask:0xf
    ds_write_b32 v232, v12
    s_mov_b64 exec, 1
    ds_add_rtn_u32 v10, v3, v4 offset:32
    s_mov_b64 exec, -1
    ds_read2st64_b32 v[12:13], v231 offset0:0 offset1:1
    ds_read2st64_b32 v[14:15], v231 offset0:2 offset1:3
    s_waitcnt lgkmcnt(2)
    v_cmp_ne_u32 vcc, 3, v10
    s_bitcmp1_b32 vcc_lo, 0
    s_cbranch_scc1 L_s2r
    s_waitcnt lgkmcnt(0)
    v_pk_add_f32 v[12:13], v[12:13], v[14:15]
    v_add_f32 v12, v12, v13
    v_bfi_b32 v12, v9, v227, v12
    buffer_store_dword v12, v5, s[16:19], s59 offen sc1
L_s2r:
    s_waitcnt lgkmcnt(0)
    s_mov_b32 s72, 131072
    s_cmp_eq_u32 s56, 0
    s_cselect_b32 s72, 2048, s72
    s_cmp_eq_u32 s56, 1
    s_cselect_b32 s72, 129024, s72
    s_mov_b64 exec, -1
    s_add_u32 s56, s56, 1
    v_add_u32 v3, 4, v3
    s_add_u32 s58, s58, s72
    s_add_u32 s59, s59, 20480
    v_add_u32 v231, 1024, v231
    v_add_u32 v232, 1024, v232
    s_cmp_lt_u32 s56, 4
    s_cbranch_scc1 L_s2b
    s_branch L_fin
L_ffn:
    s_lshr_b32 s72, s4, 1
    s_and_b32 s72, s72, 14
    s_and_b32 s73, s4, 1
    s_or_b32 s72, s72, s73
    s_lshl_b32 s73, s4, 3
    s_and_b32 s73, s73, 16
    s_or_b32 s4, s72, s73
    s_cmp_ge_u32 s4, 12
    s_cbranch_scc1 L_s5
    s_mov_b32 s57, 1
    v_mul_u32_u24 v2, 3072, v5
    v_and_b32 v1, 15, v0
    v_lshl_add_u32 v2, v1, 4, v2
    s_lshl_b32 s72, s4, 2
    s_add_u32 s72, s72, s3
    s_lshl_b32 s75, s72, 6
    v_and_b32 v8, 31, v0
    v_lshlrev_b32 v10, 1, v8
    v_lshlrev_b32 v8, 2, v8
    buffer_load_ushort v63, v10, s[48:51], s75 offen
    s_lshl_b32 s59, s72, 7
    s_add_u32 s59, s59, 3670016
    v_lshlrev_b32 v10, 8, v6
    v_lshl_add_u32 v10, v7, 3, v10
    s_lshl_b32 s72, s3, 6
    v_add_u32 v10, s72, v10
    v_add_u32 v11, 49152, v10
    s_lshl_b32 s73, s4, 8
    s_mul_i32 s75, s3, 245760
    s_add_u32 s73, s73, s75
    s_mul_i32 s74, s3, 20480
    s_add_u32 s75, s74, 20480
L_dw10:
    s_mov_b32 m0, s74
    s_add_u32 s74, s74, 1024
    buffer_load_dwordx4 v2, s[36:39], s73 offen nt lds
    s_add_u32 s73, s73, 12288
    s_waitcnt vmcnt(1)
    s_cmp_lt_u32 s74, s75
    s_cbranch_scc1 L_dw10
    s_waitcnt vmcnt(0)
    s_mov_b64 exec, 1
    ds_add_u32 v3, v4 offset:8
    s_mov_b64 exec, -1
L_wr40:
    ds_read_b32 v12, v3 offset:8
    s_waitcnt lgkmcnt(0)
    v_cmp_gt_u32 vcc, 4, v12
    s_cbranch_vccz L_wr40d
    s_sleep 8
    s_branch L_wr40
L_wr40d:
    ds_read_b64_tr_b16 v[96:97], v10 offset:0
    ds_read_b64_tr_b16 v[98:99], v10 offset:512
    ds_read_b64_tr_b16 v[176:177], v10 offset:32
    ds_read_b64_tr_b16 v[178:179], v10 offset:544
    ds_read_b64_tr_b16 v[100:101], v10 offset:8192
    ds_read_b64_tr_b16 v[102:103], v10 offset:8704
    ds_read_b64_tr_b16 v[180:181], v10 offset:8224
    ds_read_b64_tr_b16 v[182:183], v10 offset:8736
    ds_read_b64_tr_b16 v[104:105], v10 offset:16384
    ds_read_b64_tr_b16 v[106:107], v10 offset:16896
    ds_read_b64_tr_b16 v[184:185], v10 offset:16416
    ds_read_b64_tr_b16 v[186:187], v10 offset:16928
    s_waitcnt lgkmcnt(0)
    ds_read_b64_tr_b16 v[108:109], v10 offset:24576
    ds_read_b64_tr_b16 v[110:111], v10 offset:25088
    ds_read_b64_tr_b16 v[188:189], v10 offset:24608
    ds_read_b64_tr_b16 v[190:191], v10 offset:25120
    ds_read_b64_tr_b16 v[112:113], v10 offset:32768
    ds_read_b64_tr_b16 v[114:115], v10 offset:33280
    ds_read_b64_tr_b16 v[192:193], v10 offset:32800
    ds_read_b64_tr_b16 v[194:195], v10 offset:33312
    ds_read_b64_tr_b16 v[116:117], v10 offset:40960
    ds_read_b64_tr_b16 v[118:119], v10 offset:41472
    ds_read_b64_tr_b16 v[196:197], v10 offset:40992
    ds_read_b64_tr_b16 v[198:199], v10 offset:41504
    s_waitcnt lgkmcnt(0)
    ds_read_b64_tr_b16 v[120:121], v11 offset:0
    ds_read_b64_tr_b16 v[122:123], v11 offset:512
    ds_read_b64_tr_b16 v[200:201], v11 offset:32
    ds_read_b64_tr_b16 v[202:203], v11 offset:544
    ds_read_b64_tr_b16 v[124:125], v11 offset:8192
    ds_read_b64_tr_b16 v[126:127], v11 offset:8704
    ds_read_b64_tr_b16 v[204:205], v11 offset:8224
    ds_read_b64_tr_b16 v[206:207], v11 offset:8736
    ds_read_b64_tr_b16 v[128:129], v11 offset:16384
    ds_read_b64_tr_b16 v[130:131], v11 offset:16896
    ds_read_b64_tr_b16 v[208:209], v11 offset:16416
    ds_read_b64_tr_b16 v[210:211], v11 offset:16928
    s_waitcnt lgkmcnt(0)
    ds_read_b64_tr_b16 v[132:133], v11 offset:24576
    ds_read_b64_tr_b16 v[134:135], v11 offset:25088
    ds_read_b64_tr_b16 v[212:213], v11 offset:24608
    ds_read_b64_tr_b16 v[214:215], v11 offset:25120
    s_waitcnt lgkmcnt(0)
    s_waitcnt vmcnt(0)
    s_mov_b64 exec, 1
    ds_add_u32 v3, v4 offset:8
    s_mov_b64 exec, -1
L_wr4x:
    ds_read_b32 v12, v3 offset:8
    s_waitcnt lgkmcnt(0)
    v_cmp_gt_u32 vcc, 8, v12
    s_cbranch_vccz L_wr4xd
    s_sleep 8
    s_branch L_wr4x
L_wr4xd:
    s_lshl_b32 s73, s4, 8
    s_mul_i32 s75, s3, 245760
    s_add_u32 s73, s73, s75
    s_add_u32 s73, s73, 983040
    s_mul_i32 s74, s3, 20480
    s_add_u32 s75, s74, 20480
L_dw11:
    s_mov_b32 m0, s74
    s_add_u32 s74, s74, 1024
    buffer_load_dwordx4 v2, s[36:39], s73 offen nt lds
    s_add_u32 s73, s73, 12288
    s_waitcnt vmcnt(1)
    s_cmp_lt_u32 s74, s75
    s_cbranch_scc1 L_dw11
    s_waitcnt vmcnt(0)
    s_mov_b64 exec, 1
    ds_add_u32 v3, v4 offset:8
    s_mov_b64 exec, -1
L_wr41:
    ds_read_b32 v12, v3 offset:8
    s_waitcnt lgkmcnt(0)
    v_cmp_gt_u32 vcc, 12, v12
    s_cbranch_vccz L_wr41d
    s_sleep 8
    s_branch L_wr41
L_wr41d:
    ds_read_b64_tr_b16 v[136:137], v10 offset:0
    ds_read_b64_tr_b16 v[138:139], v10 offset:512
    ds_read_b64_tr_b16 v[216:217], v10 offset:32
    ds_read_b64_tr_b16 v[218:219], v10 offset:544
    ds_read_b64_tr_b16 v[140:141], v10 offset:8192
    ds_read_b64_tr_b16 v[142:143], v10 offset:8704
    ds_read_b64_tr_b16 v[220:221], v10 offset:8224
    ds_read_b64_tr_b16 v[222:223], v10 offset:8736
    ds_read_b64_tr_b16 v[144:145], v10 offset:16384
    ds_read_b64_tr_b16 v[146:147], v10 offset:16896
    ds_read_b64_tr_b16 v[224:225], v10 offset:16416
    ds_read_b64_tr_b16 v[226:227], v10 offset:16928
    s_waitcnt lgkmcnt(0)
    ds_read_b64_tr_b16 v[148:149], v10 offset:24576
    ds_read_b64_tr_b16 v[150:151], v10 offset:25088
    ds_read_b64_tr_b16 v[228:229], v10 offset:24608
    ds_read_b64_tr_b16 v[230:231], v10 offset:25120
    ds_read_b64_tr_b16 v[152:153], v10 offset:32768
    ds_read_b64_tr_b16 v[154:155], v10 offset:33280
    ds_read_b64_tr_b16 v[232:233], v10 offset:32800
    ds_read_b64_tr_b16 v[234:235], v10 offset:33312
    ds_read_b64_tr_b16 v[156:157], v10 offset:40960
    ds_read_b64_tr_b16 v[158:159], v10 offset:41472
    ds_read_b64_tr_b16 v[236:237], v10 offset:40992
    ds_read_b64_tr_b16 v[238:239], v10 offset:41504
    s_waitcnt lgkmcnt(0)
    ds_read_b64_tr_b16 v[160:161], v11 offset:0
    ds_read_b64_tr_b16 v[162:163], v11 offset:512
    ds_read_b64_tr_b16 v[240:241], v11 offset:32
    ds_read_b64_tr_b16 v[242:243], v11 offset:544
    ds_read_b64_tr_b16 v[164:165], v11 offset:8192
    ds_read_b64_tr_b16 v[166:167], v11 offset:8704
    ds_read_b64_tr_b16 v[244:245], v11 offset:8224
    ds_read_b64_tr_b16 v[246:247], v11 offset:8736
    ds_read_b64_tr_b16 v[168:169], v11 offset:16384
    ds_read_b64_tr_b16 v[170:171], v11 offset:16896
    ds_read_b64_tr_b16 v[248:249], v11 offset:16416
    ds_read_b64_tr_b16 v[250:251], v11 offset:16928
    s_waitcnt lgkmcnt(0)
    ds_read_b64_tr_b16 v[172:173], v11 offset:24576
    ds_read_b64_tr_b16 v[174:175], v11 offset:25088
    ds_read_b64_tr_b16 v[252:253], v11 offset:24608
    ds_read_b64_tr_b16 v[254:255], v11 offset:25120
    s_waitcnt lgkmcnt(0)
    v_mov_b32 v24, 0x3f803f80
    v_mov_b32 v25, 0x3f803f80
    v_mov_b32 v26, 0x3f803f80
    v_mov_b32 v27, 0x3f803f80
    s_nop 1
    v_mfma_f32_16x16x32_bf16 v[72:75], v[24:27], v[96:99], 0
    v_mfma_f32_16x16x32_bf16 v[76:79], v[24:27], v[176:179], 0
    v_mfma_f32_16x16x32_bf16 v[72:75], v[24:27], v[100:103], v[72:75]
    v_mfma_f32_16x16x32_bf16 v[76:79], v[24:27], v[180:183], v[76:79]
    v_mfma_f32_16x16x32_bf16 v[72:75], v[24:27], v[104:107], v[72:75]
    v_mfma_f32_16x16x32_bf16 v[76:79], v[24:27], v[184:187], v[76:79]
    v_mfma_f32_16x16x32_bf16 v[72:75], v[24:27], v[108:111], v[72:75]
    v_mfma_f32_16x16x32_bf16 v[76:79], v[24:27], v[188:191], v[76:79]
    v_mfma_f32_16x16x32_bf16 v[72:75], v[24:27], v[112:115], v[72:75]
    v_mfma_f32_16x16x32_bf16 v[76:79], v[24:27], v[192:195], v[76:79]
    v_mfma_f32_16x16x32_bf16 v[72:75], v[24:27], v[116:119], v[72:75]
    v_mfma_f32_16x16x32_bf16 v[76:79], v[24:27], v[196:199], v[76:79]
    v_mfma_f32_16x16x32_bf16 v[72:75], v[24:27], v[120:123], v[72:75]
    v_mfma_f32_16x16x32_bf16 v[76:79], v[24:27], v[200:203], v[76:79]
    v_mfma_f32_16x16x32_bf16 v[72:75], v[24:27], v[124:127], v[72:75]
    v_mfma_f32_16x16x32_bf16 v[76:79], v[24:27], v[204:207], v[76:79]
    v_mfma_f32_16x16x32_bf16 v[72:75], v[24:27], v[128:131], v[72:75]
    v_mfma_f32_16x16x32_bf16 v[76:79], v[24:27], v[208:211], v[76:79]
    v_mfma_f32_16x16x32_bf16 v[72:75], v[24:27], v[132:135], v[72:75]
    v_mfma_f32_16x16x32_bf16 v[76:79], v[24:27], v[212:215], v[76:79]
    v_mfma_f32_16x16x32_bf16 v[72:75], v[24:27], v[136:139], v[72:75]
    v_mfma_f32_16x16x32_bf16 v[76:79], v[24:27], v[216:219], v[76:79]
    v_mfma_f32_16x16x32_bf16 v[72:75], v[24:27], v[140:143], v[72:75]
    v_mfma_f32_16x16x32_bf16 v[76:79], v[24:27], v[220:223], v[76:79]
    v_mfma_f32_16x16x32_bf16 v[72:75], v[24:27], v[144:147], v[72:75]
    v_mfma_f32_16x16x32_bf16 v[76:79], v[24:27], v[224:227], v[76:79]
    v_mfma_f32_16x16x32_bf16 v[72:75], v[24:27], v[148:151], v[72:75]
    v_mfma_f32_16x16x32_bf16 v[76:79], v[24:27], v[228:231], v[76:79]
    v_mfma_f32_16x16x32_bf16 v[72:75], v[24:27], v[152:155], v[72:75]
    v_mfma_f32_16x16x32_bf16 v[76:79], v[24:27], v[232:235], v[76:79]
    v_mfma_f32_16x16x32_bf16 v[72:75], v[24:27], v[156:159], v[72:75]
    v_mfma_f32_16x16x32_bf16 v[76:79], v[24:27], v[236:239], v[76:79]
    v_mfma_f32_16x16x32_bf16 v[72:75], v[24:27], v[160:163], v[72:75]
    v_mfma_f32_16x16x32_bf16 v[76:79], v[24:27], v[240:243], v[76:79]
    v_mfma_f32_16x16x32_bf16 v[72:75], v[24:27], v[164:167], v[72:75]
    v_mfma_f32_16x16x32_bf16 v[76:79], v[24:27], v[244:247], v[76:79]
    v_mfma_f32_16x16x32_bf16 v[72:75], v[24:27], v[168:171], v[72:75]
    v_mfma_f32_16x16x32_bf16 v[76:79], v[24:27], v[248:251], v[76:79]
    v_mfma_f32_16x16x32_bf16 v[72:75], v[24:27], v[172:175], v[72:75]
    v_mfma_f32_16x16x32_bf16 v[76:79], v[24:27], v[252:255], v[76:79]
    s_mov_b32 s30, 0xffff0000
    s_mov_b32 s31, 0xffff0000
    v_lshlrev_b32 v63, 16, v63
    s_nop 4
    v_cndmask_b32 v62, v72, v76, s[30:31]
    v_lshlrev_b32 v10, 4, v0
    v_lshrrev_b32 v60, v10, s64
    v_and_b32 v60, 0xffff, v60
    v_mov_b32 v61, 0xbdd2d3e8
    v_lshlrev_b32 v1, 4, v0
    v_lshlrev_b32 v7, 3, v0
    s_mov_b32 s48, -1
    s_mov_b32 s49, 0xff
    s_mul_i32 s61, s3, 320
    s_add_u32 s72, s61, 112448
    v_add_u32 v2, s72, v7
    s_lshl_b32 s58, s61, 1
    s_add_u32 s58, s58, 2097152
    v_and_b32 v10, 1, v0
    v_lshl_add_u32 v10, v5, 1, v10
    v_lshlrev_b32 v6, 4, v10
    v_add_u32 v6, 112448, v6
    v_and_b32 v69, 1, v0
    v_mul_u32_u24 v69, 0xaaaa, v69
    v_add_u32 v69, 0x4444, v69
    v_lshl_add_u32 v69, v69, 16, v69
    v_lshlrev_b32 v5, 2, v0
    v_add_u32 v5, 112448, v5
    s_mov_b32 s74, 0x3f803f80
    s_branch L_pre
L_s4b:
L_s4bc:
    v_mov_b32 v72, 0
    v_mov_b32 v73, 0
    v_mov_b32 v74, 0
    v_mov_b32 v75, 0
    v_mov_b32 v76, 0
    v_mov_b32 v77, 0
    v_mov_b32 v78, 0
    v_mov_b32 v79, 0
    buffer_load_dwordx2 v[64:65], v7, s[24:27], s61 offen
    v_add_u32 v84, 5120, v1
    v_add_u32 v85, 10240, v1
    v_add_u32 v86, 15360, v1
    s_mov_b64 s[8:9], s[48:49]
    s_mov_b64 s[10:11], s[48:49]
    s_mov_b64 s[12:13], s[48:49]
    s_mov_b64 s[14:15], s[48:49]
    s_mov_b64 s[28:29], s[48:49]
    s_mov_b64 s[32:33], s[48:49]
    s_mov_b64 s[34:35], s[48:49]
    s_mov_b64 s[40:41], s[48:49]
    s_waitcnt vmcnt(0)
    v_lshlrev_b32 v66, 16, v65
    v_and_b32 v67, s70, v65
    v_and_b32 v65, s70, v64
    v_lshlrev_b32 v64, 16, v64
    s_cmp_lg_u32 s56, 3
    s_cbranch_scc1 L_s4wd
L_s4w:
    ds_read_b32 v10, v3 offset:16
    s_waitcnt lgkmcnt(0)
    v_cmp_gt_u32 vcc, 4, v10
    s_cbranch_vccz L_s4wd
    s_sleep 2
    s_branch L_s4w
L_s4wd:
L_hg:
    s_wqm_b64 exec, s[8:9]
    buffer_load_dwordx4 v[24:27], v1, s[16:19], s58 offen offset:0 sc1
    s_wqm_b64 exec, s[10:11]
    buffer_load_dwordx4 v[28:31], v1, s[16:19], s58 offen offset:2560 sc1
    s_wqm_b64 exec, s[12:13]
    buffer_load_dwordx4 v[32:35], v84, s[16:19], s58 offen offset:0 sc1
    s_wqm_b64 exec, s[14:15]
    buffer_load_dwordx4 v[36:39], v84, s[16:19], s58 offen offset:2560 sc1
    s_wqm_b64 exec, s[28:29]
    buffer_load_dwordx4 v[40:43], v85, s[16:19], s58 offen offset:0 sc1
    s_wqm_b64 exec, s[32:33]
    buffer_load_dwordx4 v[44:47], v85, s[16:19], s58 offen offset:2560 sc1
    s_wqm_b64 exec, s[34:35]
    buffer_load_dwordx4 v[48:51], v86, s[16:19], s58 offen offset:0 sc1
    s_wqm_b64 exec, s[40:41]
    buffer_load_dwordx4 v[52:55], v86, s[16:19], s58 offen offset:2560 sc1
    s_mov_b64 exec, s[48:49]
    s_waitcnt vmcnt(0)
    v_xor_b32 v10, s64, v24
    v_xor_b32 v11, s64, v28
    v_xor_b32 v12, s64, v32
    v_xor_b32 v13, s64, v36
    v_xor_b32 v14, s64, v40
    v_xor_b32 v15, s64, v44
    v_xor_b32 v16, s64, v48
    v_xor_b32 v17, s64, v52
    v_bitop3_b32 v10, v10, v25, s65 bitop3:0xf6
    v_bitop3_b32 v11, v11, v29, s65 bitop3:0xf6
    v_bitop3_b32 v12, v12, v33, s65 bitop3:0xf6
    v_bitop3_b32 v13, v13, v37, s65 bitop3:0xf6
    v_bitop3_b32 v14, v14, v41, s65 bitop3:0xf6
    v_bitop3_b32 v15, v15, v45, s65 bitop3:0xf6
    v_bitop3_b32 v16, v16, v49, s65 bitop3:0xf6
    v_bitop3_b32 v17, v17, v53, s65 bitop3:0xf6
    v_bitop3_b32 v10, v10, v26, s66 bitop3:0xf6
    v_bitop3_b32 v11, v11, v30, s66 bitop3:0xf6
    v_bitop3_b32 v12, v12, v34, s66 bitop3:0xf6
    v_bitop3_b32 v13, v13, v38, s66 bitop3:0xf6
    v_bitop3_b32 v14, v14, v42, s66 bitop3:0xf6
    v_bitop3_b32 v15, v15, v46, s66 bitop3:0xf6
    v_bitop3_b32 v16, v16, v50, s66 bitop3:0xf6
    v_bitop3_b32 v17, v17, v54, s66 bitop3:0xf6
    v_bitop3_b32 v10, v10, v27, s67 bitop3:0xf6
    v_bitop3_b32 v11, v11, v31, s67 bitop3:0xf6
    v_bitop3_b32 v12, v12, v35, s67 bitop3:0xf6
    v_bitop3_b32 v13, v13, v39, s67 bitop3:0xf6
    v_bitop3_b32 v14, v14, v43, s67 bitop3:0xf6
    v_bitop3_b32 v15, v15, v47, s67 bitop3:0xf6
    v_bitop3_b32 v16, v16, v51, s67 bitop3:0xf6
    v_bitop3_b32 v17, v17, v55, s67 bitop3:0xf6
    v_cmp_ne_u32_sdwa s[8:9], v10, v72 src0_sel:BYTE_0 src1_sel:DWORD
    v_cmp_ne_u32_sdwa s[10:11], v11, v72 src0_sel:BYTE_0 src1_sel:DWORD
    v_cmp_ne_u32_sdwa s[12:13], v12, v72 src0_sel:BYTE_0 src1_sel:DWORD
    v_cmp_ne_u32_sdwa s[14:15], v13, v72 src0_sel:BYTE_0 src1_sel:DWORD
    v_cmp_ne_u32_sdwa s[28:29], v14, v72 src0_sel:BYTE_0 src1_sel:DWORD
    v_cmp_ne_u32_sdwa s[32:33], v15, v72 src0_sel:BYTE_0 src1_sel:DWORD
    v_cmp_ne_u32_sdwa s[34:35], v16, v72 src0_sel:BYTE_0 src1_sel:DWORD
    v_cmp_ne_u32_sdwa s[40:41], v17, v72 src0_sel:BYTE_0 src1_sel:DWORD
    s_mov_b32 s72, 0
    s_cmp_lg_u64 s[8:9], 0
    s_addc_u32 s72, s72, s72
    s_cmp_lg_u64 s[10:11], 0
    s_addc_u32 s72, s72, s72
    s_cmp_lg_u64 s[12:13], 0
    s_addc_u32 s72, s72, s72
    s_cmp_lg_u64 s[14:15], 0
    s_addc_u32 s72, s72, s72
    s_cmp_lg_u64 s[28:29], 0
    s_addc_u32 s72, s72, s72
    s_cmp_lg_u64 s[32:33], 0
    s_addc_u32 s72, s72, s72
    s_cmp_lg_u64 s[34:35], 0
    s_addc_u32 s72, s72, s72
    s_cmp_lg_u64 s[40:41], 0
    s_addc_u32 s72, s72, s72
    s_bcnt1_i32_b32 s73, s72
    s_cbranch_scc0 L_hall
    s_sub_u32 s68, s68, 1
    s_cbranch_scc1 L_hall
    s_cmp_le_u32 s73, 3
    s_cbranch_scc1 L_hone
    s_cmp_eq_u32 s56, 3
    s_cbranch_scc1 L_hg
    s_sleep 32
    s_branch L_hg
L_hall:
    v_pk_add_f32 v[24:25], v[24:25], v[28:29]
    v_pk_add_f32 v[26:27], v[26:27], v[30:31]
    v_pk_add_f32 v[32:33], v[32:33], v[36:37]
    v_pk_add_f32 v[34:35], v[34:35], v[38:39]
    v_pk_add_f32 v[40:41], v[40:41], v[44:45]
    v_pk_add_f32 v[42:43], v[42:43], v[46:47]
    v_pk_add_f32 v[48:49], v[48:49], v[52:53]
    v_pk_add_f32 v[50:51], v[50:51], v[54:55]
    v_pk_add_f32 v[20:21], v[24:25], v[32:33]
    v_pk_add_f32 v[22:23], v[26:27], v[34:35]
    v_pk_add_f32 v[56:57], v[40:41], v[48:49]
    v_pk_add_f32 v[58:59], v[42:43], v[50:51]
    s_branch L_hsum
L_hone:
    s_cmp_lg_u32 s72, 0
    s_cselect_b64 s[36:37], s[48:49], 0
    s_ff1_i32_b32 s73, s72
    s_bitset0_b32 s72, s73
    s_mul_i32 s73, s73, -2560
    s_add_u32 s73, s73, s58
    s_add_u32 s76, s73, 17920
    s_cmp_lg_u32 s72, 0
    s_cselect_b64 s[38:39], s[48:49], 0
    s_ff1_i32_b32 s73, s72
    s_bitset0_b32 s72, s73
    s_mul_i32 s73, s73, -2560
    s_add_u32 s73, s73, s58
    s_add_u32 s77, s73, 17920
    v_and_b32 v88, s64, v9
    v_and_b32 v89, s65, v9
    v_and_b32 v90, s66, v9
    v_and_b32 v91, s67, v9
    s_cmp_lg_u32 s72, 0
    s_cselect_b64 s[42:43], s[48:49], 0
    s_ff1_i32_b32 s73, s72
    s_bitset0_b32 s72, s73
    s_mul_i32 s73, s73, -2560
    s_add_u32 s73, s73, s58
    s_add_u32 s78, s73, 17920
    v_and_b32 v92, s64, v9
    v_and_b32 v93, s65, v9
    v_and_b32 v94, s66, v9
    v_and_b32 v95, s67, v9
    s_wqm_b64 exec, s[36:37]
    buffer_load_dwordx4 v[56:59], v1, s[16:19], s76 offen sc1
    s_wqm_b64 exec, s[38:39]
    buffer_load_dwordx4 v[88:91], v1, s[16:19], s77 offen sc1
    s_wqm_b64 exec, s[42:43]
    buffer_load_dwordx4 v[92:95], v1, s[16:19], s78 offen sc1
    s_mov_b64 exec, s[48:49]
    v_mov_b32 v20, 0
    v_mov_b32 v21, 0
    v_mov_b32 v22, 0
    v_mov_b32 v23, 0
    s_cmp_eq_u64 s[8:9], 0
    s_cselect_b64 exec, s[48:49], 0
    v_pk_add_f32 v[20:21], v[20:21], v[24:25]
    v_pk_add_f32 v[22:23], v[22:23], v[26:27]
    s_cmp_eq_u64 s[10:11], 0
    s_cselect_b64 exec, s[48:49], 0
    v_pk_add_f32 v[20:21], v[20:21], v[28:29]
    v_pk_add_f32 v[22:23], v[22:23], v[30:31]
    s_cmp_eq_u64 s[12:13], 0
    s_cselect_b64 exec, s[48:49], 0
    v_pk_add_f32 v[20:21], v[20:21], v[32:33]
    v_pk_add_f32 v[22:23], v[22:23], v[34:35]
    s_cmp_eq_u64 s[14:15], 0
    s_cselect_b64 exec, s[48:49], 0
    v_pk_add_f32 v[20:21], v[20:21], v[36:37]
    v_pk_add_f32 v[22:23], v[22:23], v[38:39]
    s_cmp_eq_u64 s[28:29], 0
    s_cselect_b64 exec, s[48:49], 0
    v_pk_add_f32 v[20:21], v[20:21], v[40:41]
    v_pk_add_f32 v[22:23], v[22:23], v[42:43]
    s_cmp_eq_u64 s[32:33], 0
    s_cselect_b64 exec, s[48:49], 0
    v_pk_add_f32 v[20:21], v[20:21], v[44:45]
    v_pk_add_f32 v[22:23], v[22:23], v[46:47]
    s_cmp_eq_u64 s[34:35], 0
    s_cselect_b64 exec, s[48:49], 0
    v_pk_add_f32 v[20:21], v[20:21], v[48:49]
    v_pk_add_f32 v[22:23], v[22:23], v[50:51]
    s_cmp_eq_u64 s[40:41], 0
    s_cselect_b64 exec, s[48:49], 0
    v_pk_add_f32 v[20:21], v[20:21], v[52:53]
    v_pk_add_f32 v[22:23], v[22:23], v[54:55]
    s_branch L_honw
L_hons:
    s_sub_u32 s68, s68, 1
    s_cbranch_scc1 L_hsum
    s_cmp_eq_u32 s56, 3
    s_cbranch_scc1 L_honl
    s_sleep 32
L_honl:
    s_wqm_b64 exec, s[36:37]
    buffer_load_dwordx4 v[56:59], v1, s[16:19], s76 offen sc1
    s_wqm_b64 exec, s[38:39]
    buffer_load_dwordx4 v[88:91], v1, s[16:19], s77 offen sc1
    s_wqm_b64 exec, s[42:43]
    buffer_load_dwordx4 v[92:95], v1, s[16:19], s78 offen sc1
L_honw:
    s_mov_b64 exec, s[48:49]
    s_waitcnt vmcnt(0)
    v_xor_b32 v10, s64, v56
    v_xor_b32 v11, s64, v88
    v_xor_b32 v12, s64, v92
    v_bitop3_b32 v10, v10, v57, s65 bitop3:0xf6
    v_bitop3_b32 v11, v11, v89, s65 bitop3:0xf6
    v_bitop3_b32 v12, v12, v93, s65 bitop3:0xf6
    v_bitop3_b32 v10, v10, v58, s66 bitop3:0xf6
    v_bitop3_b32 v11, v11, v90, s66 bitop3:0xf6
    v_bitop3_b32 v12, v12, v94, s66 bitop3:0xf6
    v_bitop3_b32 v10, v10, v59, s67 bitop3:0xf6
    v_bitop3_b32 v11, v11, v91, s67 bitop3:0xf6
    v_bitop3_b32 v12, v12, v95, s67 bitop3:0xf6
    v_cmp_ne_u32_sdwa s[36:37], v10, v72 src0_sel:BYTE_0 src1_sel:DWORD
    v_cmp_ne_u32_sdwa s[38:39], v11, v72 src0_sel:BYTE_0 src1_sel:DWORD
    v_cmp_ne_u32_sdwa s[42:43], v12, v72 src0_sel:BYTE_0 src1_sel:DWORD
    v_pk_add_f32 v[24:25], v[88:89], v[92:93]
    v_pk_add_f32 v[26:27], v[90:91], v[94:95]
    s_or_b64 vcc, s[36:37], s[38:39]
    s_or_b64 vcc, vcc, s[42:43]
    s_cbranch_scc1 L_hons
    v_pk_add_f32 v[20:21], v[20:21], v[24:25]
    v_pk_add_f32 v[22:23], v[22:23], v[26:27]
L_hsum:
    v_pk_add_f32 v[20:21], v[20:21], v[56:57]
    v_pk_add_f32 v[22:23], v[22:23], v[58:59]
    v_cvt_pk_bf16_f32 v20, 0, v20
    v_cvt_pk_bf16_f32 v21, 0, v21
    v_cvt_pk_bf16_f32 v22, 0, v22
    v_cvt_pk_bf16_f32 v23, 0, v23
    v_pk_add_f32 v[20:21], v[20:21], v[64:65]
    v_pk_add_f32 v[22:23], v[22:23], v[66:67]
    v_cvt_pk_bf16_f32 v20, v20, v21
    v_cvt_pk_bf16_f32 v21, v22, v23
    ds_write_b64 v2, v[20:21]
    s_mov_b32 s68, 16384
    s_mov_b64 exec, 1
    ds_add_u32 v3, v4 offset:32
    s_mov_b64 exec, -1
L_s4s:
    ds_read_b32 v10, v3 offset:32
    s_waitcnt lgkmcnt(0)
    v_cmp_gt_u32 vcc, 4, v10
    s_cbranch_vccnz L_s4s
    ds_read_b32 v64, v5 offset:0
    ds_read_b32 v65, v5 offset:256
    ds_read_b32 v66, v5 offset:512
    ds_read_b32 v67, v5 offset:768
    ds_read_b32 v68, v5 offset:1024
    ds_read_b128 v[24:27], v6 offset:0
    ds_read_b128 v[28:31], v6 offset:128
    ds_read_b128 v[32:35], v6 offset:256
    ds_read_b128 v[36:39], v6 offset:384
    ds_read_b128 v[40:43], v6 offset:512
    ds_read_b128 v[44:47], v6 offset:640
    ds_read_b128 v[48:51], v6 offset:768
    ds_read_b128 v[52:55], v6 offset:896
    ds_read_b128 v[56:59], v6 offset:1024
    ds_read_b128 v[80:83], v6 offset:1152
    s_waitcnt lgkmcnt(10)
    v_dot2_f32_bf16 v20, v64, s74, 0
    v_dot2_f32_bf16 v22, v64, v64, 0
    v_dot2_f32_bf16 v20, v65, s74, v20
    v_dot2_f32_bf16 v22, v65, v65, v22
    s_waitcnt lgkmcnt(9)
    v_smfmac_f32_16x16x64_bf16 v[72:75], v[24:27], v[96:103], v69
    v_dot2_f32_bf16 v20, v66, s74, v20
    v_dot2_f32_bf16 v22, v66, v66, v22
    v_smfmac_f32_16x16x64_bf16 v[76:79], v[24:27], v[176:183], v69
    v_dot2_f32_bf16 v20, v67, s74, v20
    v_dot2_f32_bf16 v22, v67, v67, v22
    s_waitcnt lgkmcnt(8)
    v_smfmac_f32_16x16x64_bf16 v[72:75], v[28:31], v[104:111], v69
    v_dot2_f32_bf16 v20, v68, s74, v20
    v_dot2_f32_bf16 v22, v68, v68, v22
    v_smfmac_f32_16x16x64_bf16 v[76:79], v[28:31], v[184:191], v69
    s_nop 1
    v_permlane32_swap_b32 v20, v22
    v_add_f32 v20, v20, v22
    s_waitcnt lgkmcnt(7)
    v_smfmac_f32_16x16x64_bf16 v[72:75], v[32:35], v[112:119], v69
    v_mov_b32 v22, v20
    v_smfmac_f32_16x16x64_bf16 v[76:79], v[32:35], v[192:199], v69
    s_nop 0
    v_permlane16_swap_b32 v20, v22
    v_add_f32 v20, v20, v22
    s_waitcnt lgkmcnt(6)
    v_smfmac_f32_16x16x64_bf16 v[72:75], v[36:39], v[120:127], v69
    v_add_f32_dpp v20, v20, v20 quad_perm:[1,0,3,2] row_mask:0xf bank_mask:0xf
    v_smfmac_f32_16x16x64_bf16 v[76:79], v[36:39], v[200:207], v69
    s_nop 0
    v_add_f32_dpp v20, v20, v20 quad_perm:[2,3,0,1] row_mask:0xf bank_mask:0xf
    s_waitcnt lgkmcnt(5)
    v_smfmac_f32_16x16x64_bf16 v[72:75], v[40:43], v[128:135], v69
    v_add_f32_dpp v20, v20, v20 row_half_mirror row_mask:0xf bank_mask:0xf
    v_smfmac_f32_16x16x64_bf16 v[76:79], v[40:43], v[208:215], v69
    s_nop 0
    v_add_f32_dpp v20, v20, v20 row_ror:8 row_mask:0xf bank_mask:0xf
    v_mul_f32 v20, 0x3acccccd, v20
    s_waitcnt lgkmcnt(4)
    v_smfmac_f32_16x16x64_bf16 v[72:75], v[44:47], v[136:143], v69
    v_mov_b32 v22, v20
    v_smfmac_f32_16x16x64_bf16 v[76:79], v[44:47], v[216:223], v69
    s_nop 0
    v_permlane32_swap_b32 v20, v22
    v_fma_f32 v22, -v20, v20, v22
    s_waitcnt lgkmcnt(3)
    v_smfmac_f32_16x16x64_bf16 v[72:75], v[48:51], v[144:151], v69
    v_cvt_pk_bf16_f32 v20, 0, v20
    v_max_f32 v22, 0, v22
    v_smfmac_f32_16x16x64_bf16 v[76:79], v[48:51], v[224:231], v69
    v_cvt_pk_bf16_f32 v22, 0, v22
    v_add_f32 v22, 0x3727c5ac, v22
    s_waitcnt lgkmcnt(2)
    v_smfmac_f32_16x16x64_bf16 v[72:75], v[52:55], v[152:159], v69
    v_cvt_pk_bf16_f32 v22, 0, v22
    v_sqrt_f32 v22, v22
    v_smfmac_f32_16x16x64_bf16 v[76:79], v[52:55], v[232:239], v69
    v_cvt_pk_bf16_f32 v22, 0, v22
    v_rcp_f32 v22, v22
    s_waitcnt lgkmcnt(1)
    v_smfmac_f32_16x16x64_bf16 v[72:75], v[56:59], v[160:167], v69
    v_smfmac_f32_16x16x64_bf16 v[76:79], v[56:59], v[240:247], v69
    s_waitcnt lgkmcnt(0)
    v_smfmac_f32_16x16x64_bf16 v[72:75], v[80:83], v[168:175], v69
    v_smfmac_f32_16x16x64_bf16 v[76:79], v[80:83], v[248:255], v69
    s_add_u32 s72, s59, 196608
    s_mov_b32 exec_hi, 0
    s_cmp_lg_u32 s56, 3
    s_nop 3
    v_add_f32 v10, v72, v73
    v_add_f32 v11, v76, v77
    v_cndmask_b32 v10, v10, v11, s[30:31]
    v_fma_f32 v10, -v20, v62, v10
    v_mul_f32 v10, v22, v10
    v_cvt_pk_bf16_f32 v10, 0, v10
    v_add_f32 v10, v10, v63
    v_cvt_pk_bf16_f32 v10, 0, v10
    v_mul_f32 v11, v10, v10
    v_fmaak_f32 v11, v61, v11, 0xc0135761
    v_mul_f32 v11, v11, v10
    v_exp_f32 v11, v11
    s_nop 0
    v_add_f32 v11, 1.0, v11
    v_rcp_f32 v11, v11
    s_nop 0
    v_mul_f32 v10, v10, v11
    v_cvt_pk_bf16_f32 v10, 0, v10
    v_or_b32 v10, v60, v10
    s_cbranch_scc1 L_s4p
    buffer_store_dword v10, v8, s[16:19], s72 offen
L_s4p:
    buffer_store_dword v10, v8, s[16:19], s59 offen sc1
L_s4r:
    s_mov_b64 exec, -1
    s_add_u32 s56, s56, 1
    v_add_u32 v3, 4, v3
    s_add_u32 s58, s58, 20480
    s_add_u32 s59, s59, 6144
    s_add_u32 s61, s61, 1280
    v_add_u32 v2, 1536, v2
    v_add_u32 v5, 1536, v5
    v_add_u32 v6, 1536, v6
    s_cmp_lt_u32 s56, 4
    s_cbranch_scc1 L_s4b
    s_branch L_fin
L_s5:
    s_mov_b32 s57, 2
    s_sub_u32 s72, s4, 12
    s_lshl_b32 s61, s72, 6
    s_lshl_b32 s58, s72, 7
    s_add_u32 s58, s58, 2097152
    s_mul_i32 s60, s3, 1536
    s_add_u32 s60, s60, 3670016
    v_lshrrev_b32 v2, 2, v0
    v_mul_u32_u24 v2, 1280, v2
    v_lshl_add_u32 v2, v7, 4, v2
    s_mul_i32 s73, s3, 491520
    s_add_u32 s73, s73, s61
    v_lshlrev_b32 v10, 6, v6
    v_lshl_add_u32 v10, v7, 3, v10
    v_add_u32 v12, s74, v10
    s_add_u32 s75, s74, 24576
L_dw2:
    s_mov_b32 m0, s74
    s_add_u32 s74, s74, 1024
    buffer_load_dwordx4 v2, s[40:43], s73 offen nt lds
    s_add_u32 s73, s73, 20480
    s_waitcnt vmcnt(1)
    s_cmp_lt_u32 s74, s75
    s_cbranch_scc1 L_dw2
    v_lshrrev_b32 v1, 3, v0
    v_mul_u32_u24 v1, 2560, v1
    v_and_b32 v10, 7, v0
    v_lshl_add_u32 v1, v10, 4, v1
    v_lshlrev_b32 v7, 3, v10
    v_lshl_add_u32 v7, v5, 1, v7
    buffer_load_dword v67, v63, s[52:55], s61 offen
    v_bfe_u32 v2, v0, 1, 3
    v_min_u32 v2, 5, v2
    v_lshl_add_u32 v2, v2, 2, v5
    v_and_b32 v10, 1, v0
    v_lshl_add_u32 v2, v2, 1, v10
    v_lshlrev_b32 v2, 5, v2
    v_and_b32 v60, 1, v0
    v_mul_u32_u24 v60, 0xaaaa, v60
    v_add_u32 v60, 0x4444, v60
    v_lshl_add_u32 v60, v60, 16, v60
    s_lshl_b32 s72, s3, 7
    s_add_u32 s72, s72, 112448
    v_add_u32 v5, s72, v63
    v_lshlrev_b32 v6, 1, v63
    v_add_u32 v6, 112448, v6
    v_lshlrev_b32 v62, 1, v7
    v_add_u32 v62, 116544, v62
    v_add_u32 v61, 4096, v6
    v_mov_b32 v8, 0xffff
    s_mov_b32 s74, 0x07060302
    s_waitcnt vmcnt(0)
    ds_read_b64_tr_b16 v[128:129], v12 offset:0
    ds_read_b64_tr_b16 v[130:131], v12 offset:128
    ds_read_b64_tr_b16 v[136:137], v12 offset:32
    ds_read_b64_tr_b16 v[138:139], v12 offset:160
    ds_read_b64_tr_b16 v[132:133], v12 offset:2048
    ds_read_b64_tr_b16 v[134:135], v12 offset:2176
    ds_read_b64_tr_b16 v[140:141], v12 offset:2080
    ds_read_b64_tr_b16 v[142:143], v12 offset:2208
    ds_read_b64_tr_b16 v[144:145], v12 offset:4096
    ds_read_b64_tr_b16 v[146:147], v12 offset:4224
    ds_read_b64_tr_b16 v[152:153], v12 offset:4128
    ds_read_b64_tr_b16 v[154:155], v12 offset:4256
    s_waitcnt lgkmcnt(0)
    ds_read_b64_tr_b16 v[148:149], v12 offset:6144
    ds_read_b64_tr_b16 v[150:151], v12 offset:6272
    ds_read_b64_tr_b16 v[156:157], v12 offset:6176
    ds_read_b64_tr_b16 v[158:159], v12 offset:6304
    ds_read_b64_tr_b16 v[160:161], v12 offset:8192
    ds_read_b64_tr_b16 v[162:163], v12 offset:8320
    ds_read_b64_tr_b16 v[168:169], v12 offset:8224
    ds_read_b64_tr_b16 v[170:171], v12 offset:8352
    ds_read_b64_tr_b16 v[164:165], v12 offset:10240
    ds_read_b64_tr_b16 v[166:167], v12 offset:10368
    ds_read_b64_tr_b16 v[172:173], v12 offset:10272
    ds_read_b64_tr_b16 v[174:175], v12 offset:10400
    s_waitcnt lgkmcnt(0)
    ds_read_b64_tr_b16 v[176:177], v12 offset:12288
    ds_read_b64_tr_b16 v[178:179], v12 offset:12416
    ds_read_b64_tr_b16 v[184:185], v12 offset:12320
    ds_read_b64_tr_b16 v[186:187], v12 offset:12448
    ds_read_b64_tr_b16 v[180:181], v12 offset:14336
    ds_read_b64_tr_b16 v[182:183], v12 offset:14464
    ds_read_b64_tr_b16 v[188:189], v12 offset:14368
    ds_read_b64_tr_b16 v[190:191], v12 offset:14496
    ds_read_b64_tr_b16 v[192:193], v12 offset:16384
    ds_read_b64_tr_b16 v[194:195], v12 offset:16512
    ds_read_b64_tr_b16 v[200:201], v12 offset:16416
    ds_read_b64_tr_b16 v[202:203], v12 offset:16544
    s_waitcnt lgkmcnt(0)
    ds_read_b64_tr_b16 v[196:197], v12 offset:18432
    ds_read_b64_tr_b16 v[198:199], v12 offset:18560
    ds_read_b64_tr_b16 v[204:205], v12 offset:18464
    ds_read_b64_tr_b16 v[206:207], v12 offset:18592
    ds_read_b64_tr_b16 v[208:209], v12 offset:20480
    ds_read_b64_tr_b16 v[210:211], v12 offset:20608
    ds_read_b64_tr_b16 v[216:217], v12 offset:20512
    ds_read_b64_tr_b16 v[218:219], v12 offset:20640
    ds_read_b64_tr_b16 v[212:213], v12 offset:22528
    ds_read_b64_tr_b16 v[214:215], v12 offset:22656
    ds_read_b64_tr_b16 v[220:221], v12 offset:22560
    ds_read_b64_tr_b16 v[222:223], v12 offset:22688
    s_waitcnt lgkmcnt(0)
    v_lshlrev_b32 v66, 16, v67
    v_and_b32 v67, s70, v67
    s_branch L_pre
L_s5b:
L_s5bc:
    v_mov_b32 v12, 0
    v_mov_b32 v13, 0
    v_mov_b32 v14, 0
    v_mov_b32 v15, 0
    v_mov_b32 v16, 0
    v_mov_b32 v17, 0
    v_mov_b32 v18, 0
    v_mov_b32 v19, 0
    s_cmp_eq_u32 s56, 3
    s_cselect_b32 s59, 196608, 0
    s_add_u32 s59, s59, s60
    s_cmp_lg_u32 s56, 3
    s_cbranch_scc1 L_s5wd
L_s5w:
    ds_read_b32 v10, v3 offset:16
    s_waitcnt lgkmcnt(0)
    v_cmp_gt_u32 vcc, 4, v10
    s_cbranch_vccz L_s5wd
    s_sleep 2
    s_branch L_s5w
L_s5wd:
    s_cmp_lg_u32 s3, 0
    s_cbranch_scc1 L_h5w
    buffer_load_ushort v64, v7, s[24:27], s61 offen
L_h5:
    buffer_load_dwordx4 v[20:23], v1, s[16:19], s58 offen sc1
    s_waitcnt vmcnt(0)
    v_xor_b32 v10, s64, v20
    v_xor_b32 v11, s65, v21
    v_bitop3_b32 v10, v10, v22, s66 bitop3:0xf6
    v_bitop3_b32 v11, v11, v23, s67 bitop3:0xf6
    v_bitop3_b32 v10, v10, v11, v9 bitop3:0xa8
    v_cmp_ne_u32 vcc, 0, v10
    s_cbranch_vccz L_h5d
    s_sub_u32 s68, s68, 1
    s_cbranch_scc1 L_h5d
    s_cmp_eq_u32 s56, 3
    s_cbranch_scc1 L_h5
    s_sleep 32
    s_cmp_lg_u32 s56, 0
    s_cbranch_scc1 L_h5
    s_sleep 100
    s_branch L_h5
L_h5d:
    s_mov_b32 s68, 16384
    v_permlane16_swap_b32 v20, v21
    v_permlane16_swap_b32 v22, v23
    v_add_f32 v20, v20, v21
    v_add_f32 v22, v22, v23
    s_nop 1
    v_permlane32_swap_b32 v20, v22
    v_add_f32 v20, v20, v22
    s_nop 1
    v_add_f32_dpp v20, v20, v20 row_ror:8 row_mask:0xf bank_mask:0xf
    v_lshlrev_b32 v64, 16, v64
    v_cvt_pk_bf16_f32 v20, 0, v20
    v_add_f32 v64, v64, v20
    v_cvt_pk_bf16_f32 v64, 0, v64
    ds_write_b32 v62, v64
    s_mov_b64 exec, 1
    ds_add_u32 v3, v4 offset:48
    s_mov_b64 exec, -1
L_h5w:
    ds_read_b32 v10, v3 offset:48
    s_waitcnt lgkmcnt(0)
    v_cmp_gt_u32 vcc, 1, v10
    s_cbranch_vccz L_h5wd
    s_sleep 2
    s_branch L_h5w
L_h5wd:
    ds_read_b64 v[64:65], v61
    s_sleep 4
L_y5:
    s_mov_b64 s[8:9], -1
    s_mov_b64 s[10:11], -1
L_y5l:
    s_wqm_b64 exec, s[8:9]
    buffer_load_dwordx4 v[32:35], v2, s[16:19], s59 offen offset:0 sc1
    s_wqm_b64 exec, s[10:11]
    buffer_load_dwordx4 v[36:39], v2, s[16:19], s59 offen offset:16 sc1
    s_mov_b64 exec, -1
L_y5w:
    s_waitcnt vmcnt(0)
    v_xor_b32 v10, s64, v32
    v_xor_b32 v11, s64, v36
    v_bitop3_b32 v10, v10, v33, s66 bitop3:0xf6
    v_bitop3_b32 v11, v11, v37, s66 bitop3:0xf6
    v_bitop3_b32 v10, v10, v34, s64 bitop3:0xf6
    v_bitop3_b32 v11, v11, v38, s64 bitop3:0xf6
    v_bitop3_b32 v10, v10, v35, s66 bitop3:0xf6
    v_bitop3_b32 v11, v11, v39, s66 bitop3:0xf6
    v_and_b32 v10, v8, v10
    v_and_b32 v11, v8, v11
    v_cmp_ne_u32 s[8:9], 0, v10
    v_cmp_ne_u32 s[10:11], 0, v11
    s_nop 1
    s_or_b64 vcc, s[8:9], s[10:11]
    s_cbranch_scc0 L_y5d
    s_sub_u32 s68, s68, 1
    s_cbranch_scc1 L_y5d
    s_cmp_lt_u32 s68, 16372
    s_cselect_b32 s59, s60, s59
    s_cmp_eq_u32 s56, 3
    s_cbranch_scc1 L_y5l
    s_sleep 32
    s_branch L_y5l
L_y5d:
    s_mov_b32 s68, 16384
    v_perm_b32 v28, v33, v32, s74
    v_perm_b32 v29, v35, v34, s74
    v_perm_b32 v30, v37, v36, s74
    v_perm_b32 v31, v39, v38, s74
    s_nop 1
    v_smfmac_f32_16x16x64_bf16 v[12:15], v[28:31], v[128:135], v60
    v_mov_b32_dpp v72, v28 row_shl:2 row_mask:0xf bank_mask:0xf
    v_mov_b32_dpp v73, v29 row_shl:2 row_mask:0xf bank_mask:0xf
    v_mov_b32_dpp v74, v30 row_shl:2 row_mask:0xf bank_mask:0xf
    v_mov_b32_dpp v75, v31 row_shl:2 row_mask:0xf bank_mask:0xf
    v_smfmac_f32_16x16x64_bf16 v[16:19], v[28:31], v[136:143], v60
    v_mov_b32_dpp v76, v28 row_shl:4 row_mask:0xf bank_mask:0xf
    v_mov_b32_dpp v77, v29 row_shl:4 row_mask:0xf bank_mask:0xf
    v_smfmac_f32_16x16x64_bf16 v[12:15], v[72:75], v[144:151], v60
    v_mov_b32_dpp v78, v30 row_shl:4 row_mask:0xf bank_mask:0xf
    v_mov_b32_dpp v79, v31 row_shl:4 row_mask:0xf bank_mask:0xf
    v_smfmac_f32_16x16x64_bf16 v[16:19], v[72:75], v[152:159], v60
    v_mov_b32_dpp v80, v28 row_shl:6 row_mask:0xf bank_mask:0xf
    v_mov_b32_dpp v81, v29 row_shl:6 row_mask:0xf bank_mask:0xf
    v_smfmac_f32_16x16x64_bf16 v[12:15], v[76:79], v[160:167], v60
    v_mov_b32_dpp v82, v30 row_shl:6 row_mask:0xf bank_mask:0xf
    v_mov_b32_dpp v83, v31 row_shl:6 row_mask:0xf bank_mask:0xf
    v_smfmac_f32_16x16x64_bf16 v[16:19], v[76:79], v[168:175], v60
    v_mov_b32_dpp v84, v28 row_shl:8 row_mask:0xf bank_mask:0xf
    v_mov_b32_dpp v85, v29 row_shl:8 row_mask:0xf bank_mask:0xf
    v_smfmac_f32_16x16x64_bf16 v[12:15], v[80:83], v[176:183], v60
    v_mov_b32_dpp v86, v30 row_shl:8 row_mask:0xf bank_mask:0xf
    v_mov_b32_dpp v87, v31 row_shl:8 row_mask:0xf bank_mask:0xf
    v_smfmac_f32_16x16x64_bf16 v[16:19], v[80:83], v[184:191], v60
    v_mov_b32_dpp v88, v28 row_shl:10 row_mask:0xf bank_mask:0xf
    v_mov_b32_dpp v89, v29 row_shl:10 row_mask:0xf bank_mask:0xf
    v_smfmac_f32_16x16x64_bf16 v[12:15], v[84:87], v[192:199], v60
    v_mov_b32_dpp v90, v30 row_shl:10 row_mask:0xf bank_mask:0xf
    v_mov_b32_dpp v91, v31 row_shl:10 row_mask:0xf bank_mask:0xf
    v_smfmac_f32_16x16x64_bf16 v[16:19], v[84:87], v[200:207], v60
    s_nop 0
    v_smfmac_f32_16x16x64_bf16 v[12:15], v[88:91], v[208:215], v60
    v_smfmac_f32_16x16x64_bf16 v[16:19], v[88:91], v[216:223], v60
    s_mov_b64 exec, 0xffff
    s_nop 5
    v_add_f32 v12, v12, v13
    v_add_f32 v16, v16, v17
    ds_write2_b32 v5, v12, v16 offset0:0 offset1:16
    s_mov_b64 exec, 1
    ds_add_rtn_u32 v10, v3, v4 offset:32
    s_mov_b64 exec, -1
    ds_read2_b64 v[20:23], v6 offset0:0 offset1:16
    ds_read2_b64 v[24:27], v6 offset0:32 offset1:48
    s_waitcnt lgkmcnt(2)
    v_cmp_ne_u32 vcc, 3, v10
    s_bitcmp1_b32 vcc_lo, 0
    s_cbranch_scc1 L_s5e
    s_mov_b64 exec, 0xffff
    s_waitcnt lgkmcnt(1)
    v_pk_add_f32 v[20:21], v[20:21], v[22:23]
    s_waitcnt lgkmcnt(0)
    v_pk_add_f32 v[24:25], v[24:25], v[26:27]
    v_pk_add_f32 v[20:21], v[20:21], v[24:25]
    v_cvt_pk_bf16_f32 v20, 0, v20
    v_cvt_pk_bf16_f32 v21, 0, v21
    v_pk_add_f32 v[20:21], v[20:21], v[66:67]
    v_cvt_pk_bf16_f32 v20, 0, v20
    v_cvt_pk_bf16_f32 v21, 0, v21
    v_pk_add_f32 v[20:21], v[20:21], v[64:65]
    v_cvt_pk_bf16_f32 v20, v20, v21
    buffer_store_dword v20, v63, s[44:47], s61 offen
L_s5e:
    s_waitcnt lgkmcnt(0)
    s_mov_b64 exec, -1
    s_add_u32 s56, s56, 1
    v_add_u32 v3, 4, v3
    s_add_u32 s58, s58, 20480
    s_add_u32 s60, s60, 6144
    s_add_u32 s61, s61, 1280
    v_add_u32 v5, 512, v5
    v_add_u32 v6, 512, v6
    v_add_u32 v61, 128, v61
    v_add_u32 v62, 128, v62
    s_cmp_lt_u32 s56, 4
    s_cbranch_scc1 L_s5b
    s_branch L_fin
L_idle:
    s_mov_b32 s57, 3
    s_cmp_lg_u32 s3, 3
    s_cbranch_scc1 L_fin
L_pre:
    s_mov_b32 s56, 0
    s_mov_b32 s79, 1
L_pre1:
    ds_read_b32 v10, v3 offset:20
    s_waitcnt lgkmcnt(0)
    v_cmp_gt_u32 vcc, 4, v10
    s_cbranch_vccz L_pre1d
    s_sleep 16
    s_branch L_pre1
L_pre1d:
    s_cmp_lg_u32 s3, 3
    s_cbranch_scc1 L_pre4
L_pre3:
    s_mul_i32 s72, s79, 784
    s_add_u32 s72, s72, 99840
    v_and_b32 v51, 31, v0
    v_lshlrev_b32 v54, 4, v51
    v_add_u32 v46, s72, v54
    v_mov_b32 v47, s72
    v_lshl_add_u32 v51, v51, 3, s72
    v_mov_b32 v55, 0xffff
    v_and_b32 v50, 1, v0
    v_lshlrev_b32 v50, 4, v50
    v_lshrrev_b32 v49, v50, s64
    v_sub_u32 v50, 16, v50
    s_lshl_b32 s83, s79, 17
    s_lshl_b32 s72, s2, 9
    s_add_u32 s83, s83, s72
    s_add_u32 s83, s83, 1048576
    v_mov_b32 v56, 3
    s_branch L_s1
L_pre4:
    s_bitcmp1_b32 1, s57
    s_cbranch_scc1 L_disp
L_pre2:
    v_mov_b32 v11, 112384
    s_mov_b32 s79, 2
L_pre5:
    ds_read_b32 v10, v11 offset:24
    s_waitcnt lgkmcnt(0)
    v_cmp_gt_u32 vcc, 4, v10
    s_cbranch_vccz L_pre5d
    s_sleep 16
    s_branch L_pre5
L_pre5d:
    s_cmp_eq_u32 s3, 3
    s_cbranch_scc1 L_pre3
L_disp:
    s_cmp_eq_u32 s57, 0
    s_cbranch_scc1 L_s2bc
    s_cmp_eq_u32 s57, 1
    s_cbranch_scc1 L_s4bc
    s_cmp_eq_u32 s57, 2
    s_cbranch_scc1 L_s5bc
    s_branch L_fin
L_stream:
    s_load_dwordx2 s[12:13], s[0:1], 16
    s_load_dwordx2 s[20:21], s[0:1], 88
    s_load_dwordx2 s[16:17], s[0:1], 96
    s_memrealtime s[62:63]
    s_mov_b32 s10, 402653184
    s_mov_b32 s11, 0x20000
    v_lshrrev_b32 v1, 3, v0
    v_mul_u32_u24 v1, 384, v1
    v_and_b32 v5, 7, v0
    v_lshlrev_b32 v5, 4, v5
    v_add_u32 v1, v1, v5
    s_sub_u32 s72, s3, 4
    s_mul_i32 s58, s4, 3145728
    s_lshl_b32 s74, s5, 2
    s_add_u32 s74, s74, s72
    s_mul_i32 s79, s4, 188
    s_lshr_b32 s75, s5, 2
    s_mul_i32 s75, s75, 240
    s_add_u32 s75, s75, s74
    s_add_u32 s69, s75, 16
    s_lshr_b32 s59, s75, 8
    s_lshl_b32 s75, s75, 1
    s_add_u32 s75, s75, s79
    s_lshl_b32 s73, s59, 3
    s_lshr_b32 s73, 0xec007c00, s73
    s_add_u32 s75, s75, s73
    s_and_b32 s75, s75, 255
    s_mul_i32 s75, s75, 12288
    s_mul_i32 s73, s59, 100663296
    s_add_u32 s57, s58, s75
    s_add_u32 s57, s57, s73
    s_cmp_lg_u32 s3, 7
    s_cbranch_scc1 L_noi
    s_cmp_lg_u32 s2, 6
    s_cbranch_scc1 L_non
    s_mov_b32 s22, 256
    s_mov_b32 s23, 0x20000
    v_lshlrev_b32 v8, 6, v0
    s_waitcnt lgkmcnt(0)
    s_mul_i32 s73, s62, 0x9e3779b1
    s_or_b32 s73, s73, 1
    v_mov_b32 v9, s73
    s_mov_b64 exec, 15
    buffer_store_dword v9, v8, s[20:23], 0 offen sc1
    s_mov_b64 exec, -1
L_non:
    v_mov_b32 v12, 0
    v_mov_b32 v13, 0
    v_mov_b32 v14, 0
    v_mov_b32 v15, 0
    v_and_b32 v16, 15, v0
    v_lshlrev_b32 v16, 2, v16
    v_add_u32 v16, 112384, v16
    ds_write_b32 v16, v12
    v_lshlrev_b32 v16, 4, v0
    v_lshlrev_b32 v17, 3, v0
    v_add_u32 v18, 118592, v16
    v_add_u32 v17, 119616, v17
    ds_write_b128 v18, v[12:15]
    ds_write_b64 v17, v[12:13]
    s_lshr_b32 s73, s5, 2
    s_mul_i32 s73, s73, 240
    s_lshl_b32 s75, s5, 2
    s_add_u32 s75, s75, 1
    s_add_u32 s73, s73, s75
    v_add_u32 v17, s73, v16
    v_lshlrev_b32 v16, 5, v0
    v_add_u32 v16, s75, v16
    v_cmp_gt_u32 vcc, 16, v0
    s_nop 1
    v_cndmask_b32 v16, v16, v17, vcc
    v_cmp_gt_u32 vcc, 28, v0
    s_nop 1
    v_cndmask_b32 v16, 0, v16, vcc
    v_mov_b32 v18, 0
    v_cmp_le_u32 vcc, 8, v0
    s_nop 1
    v_cndmask_b32_e64 v18, v18, 6, vcc
    v_cmp_le_u32 vcc, 16, v0
    s_nop 1
    v_cndmask_b32_e64 v18, v18, -8, vcc
    v_cmp_le_u32 vcc, 20, v0
    s_nop 1
    v_cndmask_b32_e64 v18, v18, 2, vcc
    v_cmp_le_u32 vcc, 24, v0
    s_nop 1
    v_cndmask_b32_e64 v18, v18, -12, vcc
    v_cmp_le_u32 vcc, 26, v0
    s_nop 1
    v_cndmask_b32_e64 v18, v18, 0, vcc
    v_add_lshl_u32 v17, v0, v18, 2
    v_add_u32 v17, 118592, v17
    ds_write_b32 v17, v16
L_noi:
    s_waitcnt lgkmcnt(0)
    buffer_load_dwordx4 v[20:23], v1, s[8:11], s57 offen offset:0 nt
    buffer_load_dwordx4 v[24:27], v1, s[8:11], s57 offen offset:128 nt
    buffer_load_dwordx4 v[28:31], v1, s[8:11], s57 offen offset:256 nt
    s_barrier
    s_mov_b32 s14, 402653184
    s_mov_b32 s15, 0x20000
    s_mov_b64 s[24:25], s[8:9]
    s_mov_b64 s[26:27], s[12:13]
    s_add_u32 s12, s8, 12288
    s_addc_u32 s13, s9, 0
    buffer_load_dwordx4 v[32:35], v1, s[8:11], s57 offen offset:3072 nt
    buffer_load_dwordx4 v[36:39], v1, s[8:11], s57 offen offset:3200 nt
    buffer_load_dwordx4 v[40:43], v1, s[8:11], s57 offen offset:3328 nt
    v_add_u32 v2, 6144, v1
    v_mov_b32 v4, 0
    s_add_u32 s77, s69, 16
    s_lshr_b32 s59, s69, 8
    s_lshl_b32 s69, s69, 1
    s_add_u32 s69, s69, s79
    s_lshl_b32 s73, s59, 3
    s_lshr_b32 s73, 0xec007c00, s73
    s_add_u32 s69, s69, s73
    s_and_b32 s69, s69, 255
    s_mul_i32 s69, s69, 12288
    s_mul_i32 s73, s59, 100663296
    s_add_u32 s56, s58, s69
    s_add_u32 s56, s56, s73
    s_mov_b32 s7, s74
    s_mul_i32 s74, s4, 4352
    s_add_u32 s74, s74, 3407872
    v_mov_b32 v3, s74
    s_mul_i32 s73, s59, 384
    s_add_u32 s73, s73, 98304
    v_add_u32 v5, s73, v5
    v_mov_b32 v222, 112388
    v_mov_b32 v223, 112384
    v_mov_b32 v227, 1
    s_mul_i32 s61, s72, 3136
    s_add_u32 s61, s61, 100624
    s_mov_b32 s6, 2
    s_mov_b32 s18, 4194304
    s_mov_b32 s19, 0x20000
    s_mov_b32 s70, 0xffff0000
    s_mov_b32 s71, 0x3fb8aa3b
    s_mov_b32 s68, 16384
    s_waitcnt vmcnt(3)
    buffer_load_dwordx4 v[228:231], v2, s[8:11], s57 offen offset:0 nt
    buffer_load_dwordx4 v[232:235], v2, s[8:11], s57 offen offset:128 nt
    buffer_load_dwordx4 v[236:239], v2, s[8:11], s57 offen offset:256 nt
    s_waitcnt vmcnt(3)
    buffer_load_dwordx4 v[240:243], v2, s[8:11], s57 offen offset:3072 nt
    buffer_load_dwordx4 v[244:247], v2, s[8:11], s57 offen offset:3200 nt
    buffer_load_dwordx4 v[248:251], v2, s[8:11], s57 offen offset:3328 nt
    s_waitcnt vmcnt(3)
    buffer_load_dwordx4 v[164:167], v1, s[12:15], s57 offen offset:0 nt
    buffer_load_dwordx4 v[168:171], v1, s[12:15], s57 offen offset:128 nt
    buffer_load_dwordx4 v[172:175], v1, s[12:15], s57 offen offset:256 nt
    s_waitcnt vmcnt(3)
    buffer_load_dwordx4 v[176:179], v1, s[12:15], s57 offen offset:3072 nt
    buffer_load_dwordx4 v[180:183], v1, s[12:15], s57 offen offset:3200 nt
    buffer_load_dwordx4 v[184:187], v1, s[12:15], s57 offen offset:3328 nt
    s_waitcnt vmcnt(3)
    buffer_load_dwordx4 v[188:191], v2, s[12:15], s57 offen offset:0 nt
    buffer_load_dwordx4 v[192:195], v2, s[12:15], s57 offen offset:128 nt
    buffer_load_dwordx4 v[196:199], v2, s[12:15], s57 offen offset:256 nt
    s_waitcnt vmcnt(3)
    buffer_load_dwordx4 v[200:203], v2, s[12:15], s57 offen offset:3072 nt
    buffer_load_dwordx4 v[204:207], v2, s[12:15], s57 offen offset:3200 nt
    buffer_load_dwordx4 v[208:211], v2, s[12:15], s57 offen offset:3328 nt
    s_waitcnt vmcnt(3)
    buffer_load_dwordx4 v[68:71], v1, s[8:11], s56 offen offset:0 nt
    buffer_load_dwordx4 v[72:75], v1, s[8:11], s56 offen offset:128 nt
    buffer_load_dwordx4 v[76:79], v1, s[8:11], s56 offen offset:256 nt
    s_waitcnt vmcnt(3)
    buffer_load_dwordx4 v[80:83], v1, s[8:11], s56 offen offset:3072 nt
    buffer_load_dwordx4 v[84:87], v1, s[8:11], s56 offen offset:3200 nt
    buffer_load_dwordx4 v[88:91], v1, s[8:11], s56 offen offset:3328 nt
    s_waitcnt vmcnt(3)
    buffer_load_dwordx4 v[92:95], v2, s[8:11], s56 offen offset:0 nt
    buffer_load_dwordx4 v[96:99], v2, s[8:11], s56 offen offset:128 nt
    buffer_load_dwordx4 v[100:103], v2, s[8:11], s56 offen offset:256 nt
    s_waitcnt vmcnt(3)
    buffer_load_dwordx4 v[104:107], v2, s[8:11], s56 offen offset:3072 nt
    buffer_load_dwordx4 v[108:111], v2, s[8:11], s56 offen offset:3200 nt
    buffer_load_dwordx4 v[112:115], v2, s[8:11], s56 offen offset:3328 nt
    s_waitcnt vmcnt(3)
    buffer_load_dwordx4 v[116:119], v1, s[12:15], s56 offen offset:0 nt
    buffer_load_dwordx4 v[120:123], v1, s[12:15], s56 offen offset:128 nt
    buffer_load_dwordx4 v[124:127], v1, s[12:15], s56 offen offset:256 nt
    s_waitcnt vmcnt(3)
    buffer_load_dwordx4 v[128:131], v1, s[12:15], s56 offen offset:3072 nt
    buffer_load_dwordx4 v[132:135], v1, s[12:15], s56 offen offset:3200 nt
    buffer_load_dwordx4 v[136:139], v1, s[12:15], s56 offen offset:3328 nt
    s_waitcnt vmcnt(3)
    buffer_load_dwordx4 v[140:143], v2, s[12:15], s56 offen offset:0 nt
    buffer_load_dwordx4 v[144:147], v2, s[12:15], s56 offen offset:128 nt
    buffer_load_dwordx4 v[148:151], v2, s[12:15], s56 offen offset:256 nt
    s_waitcnt vmcnt(3)
    buffer_load_dwordx4 v[152:155], v2, s[12:15], s56 offen offset:3072 nt
    buffer_load_dwordx4 v[156:159], v2, s[12:15], s56 offen offset:3200 nt
    buffer_load_dwordx4 v[160:163], v2, s[12:15], s56 offen offset:3328 nt
    s_mov_b32 s33, s59
    s_lshr_b32 s60, s77, 8
    s_and_b32 s77, s77, 255
    s_cmp_lt_u32 s60, 2
    s_cselect_b32 s30, 0, 0
    s_cselect_b32 s31, 8, 8
    s_cselect_b32 s32, 4, 5
    s_cselect_b32 s29, 0, 32
    s_lshl_b32 s31, s31, 4
    s_cmp_eq_u32 s60, 3
    s_cbranch_scc0 L_ph1
    s_mov_b32 s31, 64
    s_mov_b32 s29, 48
    s_cmp_lt_u32 s77, 128
    s_cbranch_scc1 L_ph1
    s_mov_b32 s28, 0
    s_mov_b64 s[8:9], s[24:25]
    s_mov_b64 s[12:13], s[26:27]
    s_branch L_phd1
L_ph1:
    s_sub_u32 s77, s77, s30
    s_cmp_ge_u32 s77, s31
    s_cselect_b64 s[8:9], s[26:27], s[24:25]
    s_cselect_b32 s28, 2, 1
    s_cselect_b32 s31, s31, 0
    s_sub_u32 s77, s77, s31
    s_add_u32 s12, s8, 12288
    s_addc_u32 s13, s9, 0
    s_lshr_b32 s31, s77, s32
    s_lshl2_add_u32 s29, s31, s29
    s_and_b32 s31, s77, 3
    s_add_u32 s29, s29, s31
    s_lshl1_add_u32 s77, s77, s30
L_phd1:
    s_add_u32 s77, s77, s79
    s_lshl_b32 s73, s60, 3
    s_lshr_b32 s73, 0xec007c00, s73
    s_add_u32 s77, s77, s73
    s_and_b32 s77, s77, 255
    s_mul_i32 s77, s77, 12288
    s_mul_i32 s73, s60, 100663296
    s_add_u32 s56, s58, s77
    s_add_u32 s56, s56, s73
L_wqs:
    ds_read_b32 v64, v223 offset:0
    s_waitcnt lgkmcnt(0)
    v_cmp_gt_u32 vcc, 3, v64
    s_cbranch_vccz L_wqsd
    s_sleep 1
    s_branch L_wqs
L_wqsd:
    ds_read_b128 v[8:11], v5 offset:0
    ds_read_b128 v[12:15], v5 offset:128
    ds_read_b128 v[16:19], v5 offset:256
L_nps:
    v_mov_b32 v64, 112384
    ds_read_b32 v64, v64 offset:4
    s_waitcnt lgkmcnt(0)
    v_readfirstlane_b32 s64, v64
    s_nop 1
    s_cmp_eq_u32 s64, 0
    s_cbranch_scc1 L_nps
    s_lshr_b32 s65, s64, 8
    s_lshr_b32 s66, s64, 16
    s_lshr_b32 s67, s64, 24
    v_dot2_f32_bf16 v44, v68, v8, 0
    v_dot2_f32_bf16 v45, v69, v9, 0
    v_dot2_f32_bf16 v44, v70, v10, v44
    v_dot2_f32_bf16 v45, v71, v11, v45
    v_dot2_f32_bf16 v44, v72, v12, v44
    v_dot2_f32_bf16 v45, v73, v13, v45
    v_dot2_f32_bf16 v44, v74, v14, v44
    v_dot2_f32_bf16 v45, v75, v15, v45
    v_dot2_f32_bf16 v44, v76, v16, v44
    v_dot2_f32_bf16 v45, v77, v17, v45
    v_dot2_f32_bf16 v44, v78, v18, v44
    v_dot2_f32_bf16 v45, v79, v19, v45
    s_waitcnt vmcnt(3)
    buffer_load_dwordx4 v[68:71], v1, s[8:11], s56 offen offset:0 nt
    buffer_load_dwordx4 v[72:75], v1, s[8:11], s56 offen offset:128 nt
    buffer_load_dwordx4 v[76:79], v1, s[8:11], s56 offen offset:256 nt
    v_dot2_f32_bf16 v46, v80, v8, 0
    v_dot2_f32_bf16 v47, v81, v9, 0
    v_dot2_f32_bf16 v46, v82, v10, v46
    v_dot2_f32_bf16 v47, v83, v11, v47
    v_dot2_f32_bf16 v46, v84, v12, v46
    v_dot2_f32_bf16 v47, v85, v13, v47
    v_dot2_f32_bf16 v46, v86, v14, v46
    v_dot2_f32_bf16 v47, v87, v15, v47
    v_dot2_f32_bf16 v46, v88, v16, v46
    v_dot2_f32_bf16 v47, v89, v17, v47
    v_dot2_f32_bf16 v46, v90, v18, v46
    v_dot2_f32_bf16 v47, v91, v19, v47
    v_dot2_f32_bf16 v48, v92, v8, 0
    v_dot2_f32_bf16 v49, v93, v9, 0
    v_dot2_f32_bf16 v48, v94, v10, v48
    v_dot2_f32_bf16 v49, v95, v11, v49
    v_dot2_f32_bf16 v48, v96, v12, v48
    v_dot2_f32_bf16 v49, v97, v13, v49
    v_dot2_f32_bf16 v48, v98, v14, v48
    v_dot2_f32_bf16 v49, v99, v15, v49
    v_dot2_f32_bf16 v48, v100, v16, v48
    v_dot2_f32_bf16 v49, v101, v17, v49
    v_dot2_f32_bf16 v48, v102, v18, v48
    v_dot2_f32_bf16 v49, v103, v19, v49
    v_dot2_f32_bf16 v50, v104, v8, 0
    v_dot2_f32_bf16 v51, v105, v9, 0
    v_dot2_f32_bf16 v50, v106, v10, v50
    v_dot2_f32_bf16 v51, v107, v11, v51
    v_dot2_f32_bf16 v50, v108, v12, v50
    v_dot2_f32_bf16 v51, v109, v13, v51
    v_dot2_f32_bf16 v50, v110, v14, v50
    v_dot2_f32_bf16 v51, v111, v15, v51
    v_dot2_f32_bf16 v50, v112, v16, v50
    v_dot2_f32_bf16 v51, v113, v17, v51
    v_dot2_f32_bf16 v50, v114, v18, v50
    v_dot2_f32_bf16 v51, v115, v19, v51
    v_dot2_f32_bf16 v212, v20, v8, 0
    v_dot2_f32_bf16 v213, v21, v9, 0
    v_dot2_f32_bf16 v212, v22, v10, v212
    v_dot2_f32_bf16 v213, v23, v11, v213
    v_dot2_f32_bf16 v212, v24, v12, v212
    v_dot2_f32_bf16 v213, v25, v13, v213
    v_dot2_f32_bf16 v212, v26, v14, v212
    v_dot2_f32_bf16 v213, v27, v15, v213
    v_dot2_f32_bf16 v212, v28, v16, v212
    v_dot2_f32_bf16 v213, v29, v17, v213
    v_dot2_f32_bf16 v212, v30, v18, v212
    v_dot2_f32_bf16 v213, v31, v19, v213
    v_dot2_f32_bf16 v214, v32, v8, 0
    v_dot2_f32_bf16 v215, v33, v9, 0
    v_dot2_f32_bf16 v214, v34, v10, v214
    v_dot2_f32_bf16 v215, v35, v11, v215
    v_dot2_f32_bf16 v214, v36, v12, v214
    v_dot2_f32_bf16 v215, v37, v13, v215
    v_dot2_f32_bf16 v214, v38, v14, v214
    v_dot2_f32_bf16 v215, v39, v15, v215
    v_dot2_f32_bf16 v214, v40, v16, v214
    v_dot2_f32_bf16 v215, v41, v17, v215
    v_dot2_f32_bf16 v214, v42, v18, v214
    v_dot2_f32_bf16 v215, v43, v19, v215
    v_dot2_f32_bf16 v216, v228, v8, 0
    v_dot2_f32_bf16 v217, v229, v9, 0
    v_dot2_f32_bf16 v216, v230, v10, v216
    v_dot2_f32_bf16 v217, v231, v11, v217
    v_dot2_f32_bf16 v216, v232, v12, v216
    v_dot2_f32_bf16 v217, v233, v13, v217
    v_dot2_f32_bf16 v216, v234, v14, v216
    v_dot2_f32_bf16 v217, v235, v15, v217
    v_dot2_f32_bf16 v216, v236, v16, v216
    v_dot2_f32_bf16 v217, v237, v17, v217
    v_dot2_f32_bf16 v216, v238, v18, v216
    v_dot2_f32_bf16 v217, v239, v19, v217
    v_dot2_f32_bf16 v218, v240, v8, 0
    v_dot2_f32_bf16 v219, v241, v9, 0
    v_dot2_f32_bf16 v218, v242, v10, v218
    v_dot2_f32_bf16 v219, v243, v11, v219
    v_dot2_f32_bf16 v218, v244, v12, v218
    v_dot2_f32_bf16 v219, v245, v13, v219
    v_dot2_f32_bf16 v218, v246, v14, v218
    v_dot2_f32_bf16 v219, v247, v15, v219
    v_dot2_f32_bf16 v218, v248, v16, v218
    v_dot2_f32_bf16 v219, v249, v17, v219
    v_dot2_f32_bf16 v218, v250, v18, v218
    v_dot2_f32_bf16 v219, v251, v19, v219
    v_mov_b32 v20, 0
    v_mov_b32 v21, 0
    v_mov_b32 v22, 0
    v_mov_b32 v23, 0
    v_mov_b32 v24, 0
    v_mov_b32 v25, 0
    v_mov_b32 v26, 0
    v_mov_b32 v27, 0
    v_mov_b32 v28, 0
    v_mov_b32 v29, 0
    v_mov_b32 v30, 0
    v_mov_b32 v31, 0
    v_mov_b32 v32, 0
    v_mov_b32 v33, 0
    v_mov_b32 v34, 0
    v_mov_b32 v35, 0
    v_mov_b32 v36, 0
    v_mov_b32 v37, 0
    v_mov_b32 v38, 0
    v_mov_b32 v39, 0
    v_mov_b32 v40, 0
    v_mov_b32 v41, 0
    v_mov_b32 v42, 0
    v_mov_b32 v43, 0
    v_mov_b32 v7, 0
    v_mov_b32 v6, 0xff7fffff
    s_waitcnt vmcnt(3)
    buffer_load_dwordx4 v[80:83], v1, s[8:11], s56 offen offset:3072 nt
    buffer_load_dwordx4 v[84:87], v1, s[8:11], s56 offen offset:3200 nt
    buffer_load_dwordx4 v[88:91], v1, s[8:11], s56 offen offset:3328 nt
    s_lshl_b32 s72, s3, 7
    s_add_u32 s72, s72, 119616
    v_lshrrev_b32 v60, 3, v0
    v_lshl_add_u32 v60, v60, 4, s72
    s_lshl_b32 s72, s3, 2
    s_add_u32 s72, s72, 119088
    v_mov_b32 v61, s72
    v_add_f32 v52, v212, v213
    v_add_f32 v53, v214, v215
    v_add_f32 v54, v216, v217
    v_add_f32 v55, v218, v219
    v_add_f32_dpp v52, v52, v52 quad_perm:[1,0,3,2] row_mask:0xf bank_mask:0xf
    v_add_f32_dpp v53, v53, v53 quad_perm:[1,0,3,2] row_mask:0xf bank_mask:0xf
    v_add_f32_dpp v54, v54, v54 quad_perm:[1,0,3,2] row_mask:0xf bank_mask:0xf
    v_add_f32_dpp v55, v55, v55 quad_perm:[1,0,3,2] row_mask:0xf bank_mask:0xf
    v_add_f32_dpp v52, v52, v52 quad_perm:[2,3,0,1] row_mask:0xf bank_mask:0xf
    v_add_f32_dpp v53, v53, v53 quad_perm:[2,3,0,1] row_mask:0xf bank_mask:0xf
    v_add_f32_dpp v54, v54, v54 quad_perm:[2,3,0,1] row_mask:0xf bank_mask:0xf
    v_add_f32_dpp v55, v55, v55 quad_perm:[2,3,0,1] row_mask:0xf bank_mask:0xf
    v_add_f32_dpp v52, v52, v52 row_half_mirror row_mask:0xf bank_mask:0xf
    v_add_f32_dpp v53, v53, v53 row_half_mirror row_mask:0xf bank_mask:0xf
    v_add_f32_dpp v54, v54, v54 row_half_mirror row_mask:0xf bank_mask:0xf
    v_add_f32_dpp v55, v55, v55 row_half_mirror row_mask:0xf bank_mask:0xf
    v_cvt_pk_bf16_f32 v56, v52, v53
    v_cvt_pk_bf16_f32 v57, v54, v55
    v_lshlrev_b32 v52, 16, v56
    v_and_b32 v53, s70, v56
    v_lshlrev_b32 v54, 16, v57
    v_and_b32 v55, s70, v57
    v_mul_f32 v52, 0x3d93cd3a, v52
    v_mul_f32 v53, 0x3d93cd3a, v53
    v_mul_f32 v54, 0x3d93cd3a, v54
    v_mul_f32 v55, 0x3d93cd3a, v55
    v_cvt_pk_bf16_f32 v56, v52, v53
    v_cvt_pk_bf16_f32 v57, v54, v55
    v_dot2_f32_bf16 v212, v164, v8, 0
    v_dot2_f32_bf16 v213, v165, v9, 0
    v_dot2_f32_bf16 v212, v166, v10, v212
    v_dot2_f32_bf16 v213, v167, v11, v213
    v_dot2_f32_bf16 v212, v168, v12, v212
    v_dot2_f32_bf16 v213, v169, v13, v213
    v_dot2_f32_bf16 v212, v170, v14, v212
    v_dot2_f32_bf16 v213, v171, v15, v213
    v_dot2_f32_bf16 v212, v172, v16, v212
    v_dot2_f32_bf16 v213, v173, v17, v213
    v_dot2_f32_bf16 v212, v174, v18, v212
    v_dot2_f32_bf16 v213, v175, v19, v213
    v_dot2_f32_bf16 v214, v176, v8, 0
    v_dot2_f32_bf16 v215, v177, v9, 0
    v_dot2_f32_bf16 v214, v178, v10, v214
    v_dot2_f32_bf16 v215, v179, v11, v215
    v_dot2_f32_bf16 v214, v180, v12, v214
    v_dot2_f32_bf16 v215, v181, v13, v215
    v_dot2_f32_bf16 v214, v182, v14, v214
    v_dot2_f32_bf16 v215, v183, v15, v215
    v_dot2_f32_bf16 v214, v184, v16, v214
    v_dot2_f32_bf16 v215, v185, v17, v215
    v_dot2_f32_bf16 v214, v186, v18, v214
    v_dot2_f32_bf16 v215, v187, v19, v215
    v_dot2_f32_bf16 v216, v188, v8, 0
    v_dot2_f32_bf16 v217, v189, v9, 0
    v_dot2_f32_bf16 v216, v190, v10, v216
    v_dot2_f32_bf16 v217, v191, v11, v217
    v_dot2_f32_bf16 v216, v192, v12, v216
    v_dot2_f32_bf16 v217, v193, v13, v217
    v_dot2_f32_bf16 v216, v194, v14, v216
    v_dot2_f32_bf16 v217, v195, v15, v217
    v_dot2_f32_bf16 v216, v196, v16, v216
    v_dot2_f32_bf16 v217, v197, v17, v217
    v_dot2_f32_bf16 v216, v198, v18, v216
    v_dot2_f32_bf16 v217, v199, v19, v217
    v_dot2_f32_bf16 v218, v200, v8, 0
    v_dot2_f32_bf16 v219, v201, v9, 0
    v_dot2_f32_bf16 v218, v202, v10, v218
    v_dot2_f32_bf16 v219, v203, v11, v219
    v_dot2_f32_bf16 v218, v204, v12, v218
    v_dot2_f32_bf16 v219, v205, v13, v219
    v_dot2_f32_bf16 v218, v206, v14, v218
    v_dot2_f32_bf16 v219, v207, v15, v219
    v_dot2_f32_bf16 v218, v208, v16, v218
    v_dot2_f32_bf16 v219, v209, v17, v219
    v_dot2_f32_bf16 v218, v210, v18, v218
    v_dot2_f32_bf16 v219, v211, v19, v219
    s_waitcnt vmcnt(3)
    buffer_load_dwordx4 v[92:95], v2, s[8:11], s56 offen offset:0 nt
    buffer_load_dwordx4 v[96:99], v2, s[8:11], s56 offen offset:128 nt
    buffer_load_dwordx4 v[100:103], v2, s[8:11], s56 offen offset:256 nt
    v_add_f32 v52, v212, v213
    v_add_f32 v53, v214, v215
    v_add_f32 v54, v216, v217
    v_add_f32 v55, v218, v219
    v_add_f32_dpp v52, v52, v52 quad_perm:[1,0,3,2] row_mask:0xf bank_mask:0xf
    v_add_f32_dpp v53, v53, v53 quad_perm:[1,0,3,2] row_mask:0xf bank_mask:0xf
    v_add_f32_dpp v54, v54, v54 quad_perm:[1,0,3,2] row_mask:0xf bank_mask:0xf
    v_add_f32_dpp v55, v55, v55 quad_perm:[1,0,3,2] row_mask:0xf bank_mask:0xf
    v_add_f32_dpp v52, v52, v52 quad_perm:[2,3,0,1] row_mask:0xf bank_mask:0xf
    v_add_f32_dpp v53, v53, v53 quad_perm:[2,3,0,1] row_mask:0xf bank_mask:0xf
    v_add_f32_dpp v54, v54, v54 quad_perm:[2,3,0,1] row_mask:0xf bank_mask:0xf
    v_add_f32_dpp v55, v55, v55 quad_perm:[2,3,0,1] row_mask:0xf bank_mask:0xf
    v_add_f32_dpp v52, v52, v52 row_half_mirror row_mask:0xf bank_mask:0xf
    v_add_f32_dpp v53, v53, v53 row_half_mirror row_mask:0xf bank_mask:0xf
    v_add_f32_dpp v54, v54, v54 row_half_mirror row_mask:0xf bank_mask:0xf
    v_add_f32_dpp v55, v55, v55 row_half_mirror row_mask:0xf bank_mask:0xf
    v_cvt_pk_bf16_f32 v58, v52, v53
    v_cvt_pk_bf16_f32 v59, v54, v55
    v_lshlrev_b32 v52, 16, v58
    v_and_b32 v53, s70, v58
    v_lshlrev_b32 v54, 16, v59
    v_and_b32 v55, s70, v59
    v_mul_f32 v52, 0x3d93cd3a, v52
    v_mul_f32 v53, 0x3d93cd3a, v53
    v_mul_f32 v54, 0x3d93cd3a, v54
    v_mul_f32 v55, 0x3d93cd3a, v55
    v_cvt_pk_bf16_f32 v58, v52, v53
    v_cvt_pk_bf16_f32 v59, v54, v55
    s_mov_b32 exec_lo, 0x01010101
    s_mov_b32 exec_hi, 0x01010101
    ds_write_b128 v60, v[56:59] offset:0
    s_mov_b64 exec, 1
    ds_write_b32 v61, v227 offset:0
    s_mov_b64 exec, -1
    v_add_f32 v52, v44, v45
    v_add_f32 v53, v46, v47
    v_add_f32 v54, v48, v49
    v_add_f32 v55, v50, v51
    v_add_f32_dpp v52, v52, v52 quad_perm:[1,0,3,2] row_mask:0xf bank_mask:0xf
    v_add_f32_dpp v53, v53, v53 quad_perm:[1,0,3,2] row_mask:0xf bank_mask:0xf
    v_add_f32_dpp v54, v54, v54 quad_perm:[1,0,3,2] row_mask:0xf bank_mask:0xf
    v_add_f32_dpp v55, v55, v55 quad_perm:[1,0,3,2] row_mask:0xf bank_mask:0xf
    v_add_f32_dpp v52, v52, v52 quad_perm:[2,3,0,1] row_mask:0xf bank_mask:0xf
    v_add_f32_dpp v53, v53, v53 quad_perm:[2,3,0,1] row_mask:0xf bank_mask:0xf
    v_add_f32_dpp v54, v54, v54 quad_perm:[2,3,0,1] row_mask:0xf bank_mask:0xf
    v_add_f32_dpp v55, v55, v55 quad_perm:[2,3,0,1] row_mask:0xf bank_mask:0xf
    v_add_f32_dpp v52, v52, v52 row_half_mirror row_mask:0xf bank_mask:0xf
    v_add_f32_dpp v53, v53, v53 row_half_mirror row_mask:0xf bank_mask:0xf
    v_add_f32_dpp v54, v54, v54 row_half_mirror row_mask:0xf bank_mask:0xf
    v_add_f32_dpp v55, v55, v55 row_half_mirror row_mask:0xf bank_mask:0xf
    v_cvt_pk_bf16_f32 v56, v52, v53
    v_cvt_pk_bf16_f32 v57, v54, v55
    v_lshlrev_b32 v52, 16, v56
    v_and_b32 v53, s70, v56
    v_lshlrev_b32 v54, 16, v57
    v_and_b32 v55, s70, v57
    v_mul_f32 v52, 0x3d93cd3a, v52
    v_mul_f32 v53, 0x3d93cd3a, v53
    v_mul_f32 v54, 0x3d93cd3a, v54
    v_mul_f32 v55, 0x3d93cd3a, v55
    v_cvt_pk_bf16_f32 v56, v52, v53
    v_cvt_pk_bf16_f32 v57, v54, v55
    v_dot2_f32_bf16 v44, v116, v8, 0
    v_dot2_f32_bf16 v45, v117, v9, 0
    v_dot2_f32_bf16 v44, v118, v10, v44
    v_dot2_f32_bf16 v45, v119, v11, v45
    v_dot2_f32_bf16 v44, v120, v12, v44
    v_dot2_f32_bf16 v45, v121, v13, v45
    v_dot2_f32_bf16 v44, v122, v14, v44
    v_dot2_f32_bf16 v45, v123, v15, v45
    v_dot2_f32_bf16 v44, v124, v16, v44
    v_dot2_f32_bf16 v45, v125, v17, v45
    v_dot2_f32_bf16 v44, v126, v18, v44
    v_dot2_f32_bf16 v45, v127, v19, v45
    v_dot2_f32_bf16 v46, v128, v8, 0
    v_dot2_f32_bf16 v47, v129, v9, 0
    v_dot2_f32_bf16 v46, v130, v10, v46
    v_dot2_f32_bf16 v47, v131, v11, v47
    v_dot2_f32_bf16 v46, v132, v12, v46
    v_dot2_f32_bf16 v47, v133, v13, v47
    v_dot2_f32_bf16 v46, v134, v14, v46
    v_dot2_f32_bf16 v47, v135, v15, v47
    v_dot2_f32_bf16 v46, v136, v16, v46
    v_dot2_f32_bf16 v47, v137, v17, v47
    v_dot2_f32_bf16 v46, v138, v18, v46
    v_dot2_f32_bf16 v47, v139, v19, v47
    v_dot2_f32_bf16 v48, v140, v8, 0
    v_dot2_f32_bf16 v49, v141, v9, 0
    v_dot2_f32_bf16 v48, v142, v10, v48
    v_dot2_f32_bf16 v49, v143, v11, v49
    v_dot2_f32_bf16 v48, v144, v12, v48
    v_dot2_f32_bf16 v49, v145, v13, v49
    v_dot2_f32_bf16 v48, v146, v14, v48
    v_dot2_f32_bf16 v49, v147, v15, v49
    v_dot2_f32_bf16 v48, v148, v16, v48
    v_dot2_f32_bf16 v49, v149, v17, v49
    v_dot2_f32_bf16 v48, v150, v18, v48
    v_dot2_f32_bf16 v49, v151, v19, v49
    v_dot2_f32_bf16 v50, v152, v8, 0
    v_dot2_f32_bf16 v51, v153, v9, 0
    v_dot2_f32_bf16 v50, v154, v10, v50
    v_dot2_f32_bf16 v51, v155, v11, v51
    v_dot2_f32_bf16 v50, v156, v12, v50
    v_dot2_f32_bf16 v51, v157, v13, v51
    v_dot2_f32_bf16 v50, v158, v14, v50
    v_dot2_f32_bf16 v51, v159, v15, v51
    v_dot2_f32_bf16 v50, v160, v16, v50
    v_dot2_f32_bf16 v51, v161, v17, v51
    v_dot2_f32_bf16 v50, v162, v18, v50
    v_dot2_f32_bf16 v51, v163, v19, v51
    s_waitcnt vmcnt(3)
    buffer_load_dwordx4 v[104:107], v2, s[8:11], s56 offen offset:3072 nt
    buffer_load_dwordx4 v[108:111], v2, s[8:11], s56 offen offset:3200 nt
    buffer_load_dwordx4 v[112:115], v2, s[8:11], s56 offen offset:3328 nt
    v_add_f32 v52, v44, v45
    v_add_f32 v53, v46, v47
    v_add_f32 v54, v48, v49
    v_add_f32 v55, v50, v51
    v_add_f32_dpp v52, v52, v52 quad_perm:[1,0,3,2] row_mask:0xf bank_mask:0xf
    v_add_f32_dpp v53, v53, v53 quad_perm:[1,0,3,2] row_mask:0xf bank_mask:0xf
    v_add_f32_dpp v54, v54, v54 quad_perm:[1,0,3,2] row_mask:0xf bank_mask:0xf
    v_add_f32_dpp v55, v55, v55 quad_perm:[1,0,3,2] row_mask:0xf bank_mask:0xf
    v_add_f32_dpp v52, v52, v52 quad_perm:[2,3,0,1] row_mask:0xf bank_mask:0xf
    v_add_f32_dpp v53, v53, v53 quad_perm:[2,3,0,1] row_mask:0xf bank_mask:0xf
    v_add_f32_dpp v54, v54, v54 quad_perm:[2,3,0,1] row_mask:0xf bank_mask:0xf
    v_add_f32_dpp v55, v55, v55 quad_perm:[2,3,0,1] row_mask:0xf bank_mask:0xf
    v_add_f32_dpp v52, v52, v52 row_half_mirror row_mask:0xf bank_mask:0xf
    v_add_f32_dpp v53, v53, v53 row_half_mirror row_mask:0xf bank_mask:0xf
    v_add_f32_dpp v54, v54, v54 row_half_mirror row_mask:0xf bank_mask:0xf
    v_add_f32_dpp v55, v55, v55 row_half_mirror row_mask:0xf bank_mask:0xf
    v_cvt_pk_bf16_f32 v58, v52, v53
    v_cvt_pk_bf16_f32 v59, v54, v55
    v_lshlrev_b32 v52, 16, v58
    v_and_b32 v53, s70, v58
    v_lshlrev_b32 v54, 16, v59
    v_and_b32 v55, s70, v59
    v_mul_f32 v52, 0x3d93cd3a, v52
    v_mul_f32 v53, 0x3d93cd3a, v53
    v_mul_f32 v54, 0x3d93cd3a, v54
    v_mul_f32 v55, 0x3d93cd3a, v55
    v_cvt_pk_bf16_f32 v58, v52, v53
    v_cvt_pk_bf16_f32 v59, v54, v55
    s_mov_b32 exec_lo, 0x01010101
    s_mov_b32 exec_hi, 0x01010101
    ds_write_b128 v60, v[56:59] offset:512
    s_mov_b64 exec, 1
    ds_write_b32 v61, v227 offset:16
    s_mov_b64 exec, -1
L_itemk:
    s_lshl_b32 s72, s29, 7
    s_add_u32 s72, s72, 120128
    v_lshrrev_b32 v216, 3, v0
    v_lshl_add_u32 v216, v216, 4, s72
    s_lshl_b32 s72, s29, 2
    s_add_u32 s72, s72, 119104
    v_mov_b32 v217, s72
    s_waitcnt vmcnt(3)
    s_cmp_eq_u32 s6, 2
    s_cbranch_scc1 L_k0k
    buffer_load_dwordx4 v[92:95], v2, s[8:11], s56 offen offset:0 nt
    buffer_load_dwordx4 v[96:99], v2, s[8:11], s56 offen offset:128 nt
    buffer_load_dwordx4 v[100:103], v2, s[8:11], s56 offen offset:256 nt
L_k0k:
    v_dot2_f32_bf16 v44, v68, v8, 0
    v_dot2_f32_bf16 v45, v69, v9, 0
    v_dot2_f32_bf16 v44, v70, v10, v44
    v_dot2_f32_bf16 v45, v71, v11, v45
    v_dot2_f32_bf16 v44, v72, v12, v44
    v_dot2_f32_bf16 v45, v73, v13, v45
    v_dot2_f32_bf16 v44, v74, v14, v44
    v_dot2_f32_bf16 v45, v75, v15, v45
    v_dot2_f32_bf16 v44, v76, v16, v44
    v_dot2_f32_bf16 v45, v77, v17, v45
    v_dot2_f32_bf16 v44, v78, v18, v44
    v_dot2_f32_bf16 v45, v79, v19, v45
    s_waitcnt vmcnt(3)
    s_cmp_eq_u32 s6, 2
    s_cbranch_scc1 L_k1k
    buffer_load_dwordx4 v[104:107], v2, s[8:11], s56 offen offset:3072 nt
    buffer_load_dwordx4 v[108:111], v2, s[8:11], s56 offen offset:3200 nt
    buffer_load_dwordx4 v[112:115], v2, s[8:11], s56 offen offset:3328 nt
L_k1k:
    v_dot2_f32_bf16 v46, v80, v8, 0
    v_dot2_f32_bf16 v47, v81, v9, 0
    v_dot2_f32_bf16 v46, v82, v10, v46
    v_dot2_f32_bf16 v47, v83, v11, v47
    v_dot2_f32_bf16 v46, v84, v12, v46
    v_dot2_f32_bf16 v47, v85, v13, v47
    v_dot2_f32_bf16 v46, v86, v14, v46
    v_dot2_f32_bf16 v47, v87, v15, v47
    v_dot2_f32_bf16 v46, v88, v16, v46
    v_dot2_f32_bf16 v47, v89, v17, v47
    v_dot2_f32_bf16 v46, v90, v18, v46
    v_dot2_f32_bf16 v47, v91, v19, v47
    s_mov_b64 exec, 1
    ds_add_rtn_u32 v224, v223, v227 offset:12
    s_mov_b64 exec, -1
    s_waitcnt vmcnt(3)
    s_waitcnt lgkmcnt(0)
    v_readfirstlane_b32 s69, v224
    v_and_b32 v225, -4, v224
    v_add_u32 v225, 118604, v225
    s_and_b32 s78, s69, 3
    s_cmp_lt_u32 s69, 100
    s_cselect_b32 s78, 1, s78
    s_cmp_lg_u32 s78, 0
    s_cbranch_scc1 L_noclaimk
    v_mov_b32 v4, 1
    s_mov_b64 exec, 1
    buffer_atomic_add v4, v3, s[16:19], 0 offen offset:0 sc0 sc1
    s_mov_b64 exec, -1
L_noclaimk:
    buffer_load_dwordx4 v[68:71], v1, s[12:15], s56 offen offset:0 nt
    buffer_load_dwordx4 v[72:75], v1, s[12:15], s56 offen offset:128 nt
    buffer_load_dwordx4 v[76:79], v1, s[12:15], s56 offen offset:256 nt
    v_dot2_f32_bf16 v48, v92, v8, 0
    v_dot2_f32_bf16 v49, v93, v9, 0
    v_dot2_f32_bf16 v48, v94, v10, v48
    v_dot2_f32_bf16 v49, v95, v11, v49
    v_dot2_f32_bf16 v48, v96, v12, v48
    v_dot2_f32_bf16 v49, v97, v13, v49
    v_dot2_f32_bf16 v48, v98, v14, v48
    v_dot2_f32_bf16 v49, v99, v15, v49
    v_dot2_f32_bf16 v48, v100, v16, v48
    v_dot2_f32_bf16 v49, v101, v17, v49
    v_dot2_f32_bf16 v48, v102, v18, v48
    v_dot2_f32_bf16 v49, v103, v19, v49
    s_waitcnt vmcnt(4)
    s_cmp_eq_u32 s78, 0
    s_cbranch_scc1 L_k3k
    s_waitcnt vmcnt(3)
L_k3k:
    buffer_load_dwordx4 v[80:83], v1, s[12:15], s56 offen offset:3072 nt
    buffer_load_dwordx4 v[84:87], v1, s[12:15], s56 offen offset:3200 nt
    buffer_load_dwordx4 v[88:91], v1, s[12:15], s56 offen offset:3328 nt
    v_dot2_f32_bf16 v50, v104, v8, 0
    v_dot2_f32_bf16 v51, v105, v9, 0
    v_dot2_f32_bf16 v50, v106, v10, v50
    v_dot2_f32_bf16 v51, v107, v11, v51
    v_dot2_f32_bf16 v50, v108, v12, v50
    v_dot2_f32_bf16 v51, v109, v13, v51
    v_dot2_f32_bf16 v50, v110, v14, v50
    v_dot2_f32_bf16 v51, v111, v15, v51
    v_dot2_f32_bf16 v50, v112, v16, v50
    v_dot2_f32_bf16 v51, v113, v17, v51
    v_dot2_f32_bf16 v50, v114, v18, v50
    v_dot2_f32_bf16 v51, v115, v19, v51
    buffer_load_dwordx4 v[92:95], v2, s[12:15], s56 offen offset:0 nt
    buffer_load_dwordx4 v[96:99], v2, s[12:15], s56 offen offset:128 nt
    buffer_load_dwordx4 v[100:103], v2, s[12:15], s56 offen offset:256 nt
L_midk:
    v_add_f32 v52, v44, v45
    v_add_f32 v53, v46, v47
    v_add_f32 v54, v48, v49
    v_add_f32 v55, v50, v51
    v_add_f32_dpp v52, v52, v52 quad_perm:[1,0,3,2] row_mask:0xf bank_mask:0xf
    v_add_f32_dpp v53, v53, v53 quad_perm:[1,0,3,2] row_mask:0xf bank_mask:0xf
    v_add_f32_dpp v54, v54, v54 quad_perm:[1,0,3,2] row_mask:0xf bank_mask:0xf
    v_add_f32_dpp v55, v55, v55 quad_perm:[1,0,3,2] row_mask:0xf bank_mask:0xf
    v_add_f32_dpp v52, v52, v52 quad_perm:[2,3,0,1] row_mask:0xf bank_mask:0xf
    v_add_f32_dpp v53, v53, v53 quad_perm:[2,3,0,1] row_mask:0xf bank_mask:0xf
    v_add_f32_dpp v54, v54, v54 quad_perm:[2,3,0,1] row_mask:0xf bank_mask:0xf
    v_add_f32_dpp v55, v55, v55 quad_perm:[2,3,0,1] row_mask:0xf bank_mask:0xf
    v_add_f32_dpp v52, v52, v52 row_half_mirror row_mask:0xf bank_mask:0xf
    v_add_f32_dpp v53, v53, v53 row_half_mirror row_mask:0xf bank_mask:0xf
    v_add_f32_dpp v54, v54, v54 row_half_mirror row_mask:0xf bank_mask:0xf
    v_add_f32_dpp v55, v55, v55 row_half_mirror row_mask:0xf bank_mask:0xf
    v_cvt_pk_bf16_f32 v212, v52, v53
    v_cvt_pk_bf16_f32 v213, v54, v55
    v_lshlrev_b32 v52, 16, v212
    v_and_b32 v53, s70, v212
    v_lshlrev_b32 v54, 16, v213
    v_and_b32 v55, s70, v213
    v_mul_f32 v52, 0x3d93cd3a, v52
    v_mul_f32 v53, 0x3d93cd3a, v53
    v_mul_f32 v54, 0x3d93cd3a, v54
    v_mul_f32 v55, 0x3d93cd3a, v55
    v_cvt_pk_bf16_f32 v212, v52, v53
    v_cvt_pk_bf16_f32 v213, v54, v55
    s_waitcnt vmcnt(6)
    s_cmp_lg_u32 s78, 0
    s_cbranch_scc1 L_nopubk
    s_mov_b64 exec, 1
    v_lshlrev_b32 v4, 2, v4
    v_add_u32 v4, 897, v4
    ds_write_b32 v225, v4
    s_mov_b64 exec, -1
L_nopubk:
    v_dot2_f32_bf16 v44, v68, v8, 0
    v_dot2_f32_bf16 v45, v69, v9, 0
    v_dot2_f32_bf16 v44, v70, v10, v44
    v_dot2_f32_bf16 v45, v71, v11, v45
    v_dot2_f32_bf16 v44, v72, v12, v44
    v_dot2_f32_bf16 v45, v73, v13, v45
    v_dot2_f32_bf16 v44, v74, v14, v44
    v_dot2_f32_bf16 v45, v75, v15, v45
    v_dot2_f32_bf16 v44, v76, v16, v44
    v_dot2_f32_bf16 v45, v77, v17, v45
    v_dot2_f32_bf16 v44, v78, v18, v44
    v_dot2_f32_bf16 v45, v79, v19, v45
    s_waitcnt vmcnt(3)
    buffer_load_dwordx4 v[104:107], v2, s[12:15], s56 offen offset:3072 nt
    buffer_load_dwordx4 v[108:111], v2, s[12:15], s56 offen offset:3200 nt
    buffer_load_dwordx4 v[112:115], v2, s[12:15], s56 offen offset:3328 nt
L_v1k:
    v_dot2_f32_bf16 v46, v80, v8, 0
    v_dot2_f32_bf16 v47, v81, v9, 0
    v_dot2_f32_bf16 v46, v82, v10, v46
    v_dot2_f32_bf16 v47, v83, v11, v47
    v_dot2_f32_bf16 v46, v84, v12, v46
    v_dot2_f32_bf16 v47, v85, v13, v47
    v_dot2_f32_bf16 v46, v86, v14, v46
    v_dot2_f32_bf16 v47, v87, v15, v47
    v_dot2_f32_bf16 v46, v88, v16, v46
    v_dot2_f32_bf16 v47, v89, v17, v47
    v_dot2_f32_bf16 v46, v90, v18, v46
    v_dot2_f32_bf16 v47, v91, v19, v47
    s_waitcnt vmcnt(3)
    s_mov_b64 exec, 1
    ds_read_b32 v226, v225
    s_mov_b64 exec, -1
    s_waitcnt lgkmcnt(0)
    v_readfirstlane_b32 s72, v226
    s_mov_b32 s6, 0
    s_nop 0
    s_cmp_eq_u32 s72, 0
    s_cbranch_scc1 L_sp0k
L_sp0kr:
    s_and_b32 s73, s69, 3
    s_add_u32 s72, s72, s73
    s_sub_u32 s72, s72, 1
    s_cmp_ge_u32 s72, 992
    s_cbranch_scc1 L_ktrans
    s_lshr_b32 s60, s72, 8
    s_and_b32 s72, s72, 255
    s_cmp_lt_u32 s60, 2
    s_cselect_b32 s30, 0, 0
    s_cselect_b32 s31, 8, 8
    s_cselect_b32 s32, 4, 5
    s_cselect_b32 s29, 0, 32
    s_lshl_b32 s31, s31, 4
    s_cmp_eq_u32 s60, 3
    s_cbranch_scc0 L_ph2
    s_mov_b32 s31, 64
    s_mov_b32 s29, 48
    s_cmp_lt_u32 s72, 128
    s_cbranch_scc1 L_ph2
    s_mov_b32 s28, 0
    s_mov_b64 s[8:9], s[24:25]
    s_mov_b64 s[12:13], s[26:27]
    s_branch L_phd2
L_ph2:
    s_sub_u32 s72, s72, s30
    s_cmp_ge_u32 s72, s31
    s_cselect_b64 s[8:9], s[26:27], s[24:25]
    s_cselect_b32 s28, 2, 1
    s_cselect_b32 s31, s31, 0
    s_sub_u32 s72, s72, s31
    s_add_u32 s12, s8, 12288
    s_addc_u32 s13, s9, 0
    s_lshr_b32 s31, s72, s32
    s_lshl2_add_u32 s29, s31, s29
    s_and_b32 s31, s72, 3
    s_add_u32 s29, s29, s31
    s_lshl1_add_u32 s72, s72, s30
L_phd2:
    s_add_u32 s72, s72, s79
    s_lshl_b32 s73, s60, 3
    s_lshr_b32 s73, 0xec007c00, s73
    s_add_u32 s72, s72, s73
    s_and_b32 s72, s72, 255
    s_mul_i32 s72, s72, 12288
    s_mul_i32 s73, s60, 100663296
    s_add_u32 s56, s58, s72
    s_add_u32 s56, s56, s73
    buffer_load_dwordx4 v[68:71], v1, s[8:11], s56 offen offset:0 nt
    buffer_load_dwordx4 v[72:75], v1, s[8:11], s56 offen offset:128 nt
    buffer_load_dwordx4 v[76:79], v1, s[8:11], s56 offen offset:256 nt
    v_dot2_f32_bf16 v48, v92, v8, 0
    v_dot2_f32_bf16 v49, v93, v9, 0
    v_dot2_f32_bf16 v48, v94, v10, v48
    v_dot2_f32_bf16 v49, v95, v11, v49
    v_dot2_f32_bf16 v48, v96, v12, v48
    v_dot2_f32_bf16 v49, v97, v13, v49
    v_dot2_f32_bf16 v48, v98, v14, v48
    v_dot2_f32_bf16 v49, v99, v15, v49
    v_dot2_f32_bf16 v48, v100, v16, v48
    v_dot2_f32_bf16 v49, v101, v17, v49
    v_dot2_f32_bf16 v48, v102, v18, v48
    v_dot2_f32_bf16 v49, v103, v19, v49
    s_waitcnt vmcnt(3)
    buffer_load_dwordx4 v[80:83], v1, s[8:11], s56 offen offset:3072 nt
    buffer_load_dwordx4 v[84:87], v1, s[8:11], s56 offen offset:3200 nt
    buffer_load_dwordx4 v[88:91], v1, s[8:11], s56 offen offset:3328 nt
    v_dot2_f32_bf16 v50, v104, v8, 0
    v_dot2_f32_bf16 v51, v105, v9, 0
    v_dot2_f32_bf16 v50, v106, v10, v50
    v_dot2_f32_bf16 v51, v107, v11, v51
    v_dot2_f32_bf16 v50, v108, v12, v50
    v_dot2_f32_bf16 v51, v109, v13, v51
    v_dot2_f32_bf16 v50, v110, v14, v50
    v_dot2_f32_bf16 v51, v111, v15, v51
    v_dot2_f32_bf16 v50, v112, v16, v50
    v_dot2_f32_bf16 v51, v113, v17, v51
    v_dot2_f32_bf16 v50, v114, v18, v50
    v_dot2_f32_bf16 v51, v115, v19, v51
    v_add_f32 v52, v44, v45
    v_add_f32 v53, v46, v47
    v_add_f32 v54, v48, v49
    v_add_f32 v55, v50, v51
    v_add_f32_dpp v52, v52, v52 quad_perm:[1,0,3,2] row_mask:0xf bank_mask:0xf
    v_add_f32_dpp v53, v53, v53 quad_perm:[1,0,3,2] row_mask:0xf bank_mask:0xf
    v_add_f32_dpp v54, v54, v54 quad_perm:[1,0,3,2] row_mask:0xf bank_mask:0xf
    v_add_f32_dpp v55, v55, v55 quad_perm:[1,0,3,2] row_mask:0xf bank_mask:0xf
    v_add_f32_dpp v52, v52, v52 quad_perm:[2,3,0,1] row_mask:0xf bank_mask:0xf
    v_add_f32_dpp v53, v53, v53 quad_perm:[2,3,0,1] row_mask:0xf bank_mask:0xf
    v_add_f32_dpp v54, v54, v54 quad_perm:[2,3,0,1] row_mask:0xf bank_mask:0xf
    v_add_f32_dpp v55, v55, v55 quad_perm:[2,3,0,1] row_mask:0xf bank_mask:0xf
    v_add_f32_dpp v52, v52, v52 row_half_mirror row_mask:0xf bank_mask:0xf
    v_add_f32_dpp v53, v53, v53 row_half_mirror row_mask:0xf bank_mask:0xf
    v_add_f32_dpp v54, v54, v54 row_half_mirror row_mask:0xf bank_mask:0xf
    v_add_f32_dpp v55, v55, v55 row_half_mirror row_mask:0xf bank_mask:0xf
    v_cvt_pk_bf16_f32 v214, v52, v53
    v_cvt_pk_bf16_f32 v215, v54, v55
    v_lshlrev_b32 v52, 16, v214
    v_and_b32 v53, s70, v214
    v_lshlrev_b32 v54, 16, v215
    v_and_b32 v55, s70, v215
    v_mul_f32 v52, 0x3d93cd3a, v52
    v_mul_f32 v53, 0x3d93cd3a, v53
    v_mul_f32 v54, 0x3d93cd3a, v54
    v_mul_f32 v55, 0x3d93cd3a, v55
    v_cvt_pk_bf16_f32 v214, v52, v53
    v_cvt_pk_bf16_f32 v215, v54, v55
    s_mov_b32 exec_lo, 0x01010101
    s_mov_b32 exec_hi, 0x01010101
    ds_write_b128 v216, v[212:215]
    s_mov_b64 exec, 1
    ds_write_b32 v217, v227
    s_mov_b64 exec, -1
    s_cmp_lg_u32 s28, 1
    s_cbranch_scc1 L_nk
    s_cmp_eq_u32 s60, s33
    s_cbranch_scc1 L_itemk
    s_sub_u32 s72, s60, s59
    s_mul_i32 s72, s72, 384
    v_add_u32 v218, s72, v5
    s_mov_b32 s33, s60
    ds_read_b128 v[8:11], v218 offset:0
    ds_read_b128 v[12:15], v218 offset:128
    ds_read_b128 v[16:19], v218 offset:256
    s_waitcnt lgkmcnt(0)
    s_branch L_itemk
L_nk:
    s_cmp_lg_u32 s60, s59
    s_cbranch_scc1 L_flush
L_next:
    s_cmp_eq_u32 s28, 1
    s_cbranch_scc1 L_itemk
    s_cmp_eq_u32 s28, 0
    s_cbranch_scc1 L_item
L_itemv:
    s_lshl_b32 s72, s29, 7
    s_add_u32 s72, s72, 120128
    v_lshrrev_b32 v216, 3, v0
    v_lshl_add_u32 v216, v216, 4, s72
    s_lshl_b32 s72, s29, 2
    s_add_u32 s72, s72, 119104
    v_mov_b32 v217, s72
    ds_read_b32 v218, v217
    ds_read_b128 v[212:215], v216
    s_waitcnt vmcnt(3)
    buffer_load_dwordx4 v[92:95], v2, s[8:11], s56 offen offset:0 nt
    buffer_load_dwordx4 v[96:99], v2, s[8:11], s56 offen offset:128 nt
    buffer_load_dwordx4 v[100:103], v2, s[8:11], s56 offen offset:256 nt
L_scw:
    s_waitcnt lgkmcnt(0)
    v_readfirstlane_b32 s72, v218
    s_nop 1
    s_cmp_eq_u32 s72, 0
    s_cbranch_scc1 L_scs
    v_lshlrev_b32 v52, 16, v212
    v_and_b32 v53, s70, v212
    v_lshlrev_b32 v54, 16, v213
    v_and_b32 v55, s70, v213
    v_max3_f32 v64, v52, v53, v54
    v_max_f32 v64, v64, v55
    v_mul_f32 v64, s71, v64
    v_max_f32 v64, v64, v6
    v_sub_f32 v66, v6, v64
    v_mov_b32 v6, v64
    v_fma_f32 v52, v52, s71, -v64
    v_fma_f32 v53, v53, s71, -v64
    v_fma_f32 v54, v54, s71, -v64
    v_fma_f32 v55, v55, s71, -v64
    v_exp_f32 v66, v66
    v_exp_f32 v52, v52
    v_exp_f32 v53, v53
    v_exp_f32 v54, v54
    v_exp_f32 v55, v55
    v_pk_mul_f32 v[20:21], v[20:21], v[66:67] op_sel_hi:[1,0]
    v_pk_mul_f32 v[22:23], v[22:23], v[66:67] op_sel_hi:[1,0]
    v_pk_mul_f32 v[24:25], v[24:25], v[66:67] op_sel_hi:[1,0]
    v_pk_mul_f32 v[26:27], v[26:27], v[66:67] op_sel_hi:[1,0]
    v_pk_mul_f32 v[28:29], v[28:29], v[66:67] op_sel_hi:[1,0]
    v_pk_mul_f32 v[30:31], v[30:31], v[66:67] op_sel_hi:[1,0]
    v_pk_mul_f32 v[32:33], v[32:33], v[66:67] op_sel_hi:[1,0]
    v_pk_mul_f32 v[34:35], v[34:35], v[66:67] op_sel_hi:[1,0]
    v_pk_mul_f32 v[36:37], v[36:37], v[66:67] op_sel_hi:[1,0]
    v_pk_mul_f32 v[38:39], v[38:39], v[66:67] op_sel_hi:[1,0]
    v_pk_mul_f32 v[40:41], v[40:41], v[66:67] op_sel_hi:[1,0]
    v_pk_mul_f32 v[42:43], v[42:43], v[66:67] op_sel_hi:[1,0]
    v_cvt_pk_bf16_f32 v56, v52, 0
    v_cvt_pk_bf16_f32 v58, v53, 0
    v_cvt_pk_bf16_f32 v60, v54, 0
    v_cvt_pk_bf16_f32 v62, v55, 0
    v_lshlrev_b32 v57, 16, v56
    v_lshlrev_b32 v59, 16, v58
    v_lshlrev_b32 v61, 16, v60
    v_lshlrev_b32 v63, 16, v62
    v_fma_f32 v7, v7, v66, v57
    v_add_f32 v64, v59, v61
    v_add_f32 v7, v7, v63
    v_add_f32 v7, v7, v64
    v_dot2c_f32_bf16 v20, v68, v56
    v_dot2c_f32_bf16 v21, v68, v57
    v_dot2c_f32_bf16 v22, v69, v56
    v_dot2c_f32_bf16 v23, v69, v57
    v_dot2c_f32_bf16 v24, v70, v56
    v_dot2c_f32_bf16 v25, v70, v57
    v_dot2c_f32_bf16 v26, v71, v56
    v_dot2c_f32_bf16 v27, v71, v57
    v_dot2c_f32_bf16 v28, v72, v56
    v_dot2c_f32_bf16 v29, v72, v57
    v_dot2c_f32_bf16 v30, v73, v56
    v_dot2c_f32_bf16 v31, v73, v57
    v_dot2c_f32_bf16 v32, v74, v56
    v_dot2c_f32_bf16 v33, v74, v57
    v_dot2c_f32_bf16 v34, v75, v56
    v_dot2c_f32_bf16 v35, v75, v57
    v_dot2c_f32_bf16 v36, v76, v56
    v_dot2c_f32_bf16 v37, v76, v57
    v_dot2c_f32_bf16 v38, v77, v56
    v_dot2c_f32_bf16 v39, v77, v57
    v_dot2c_f32_bf16 v40, v78, v56
    v_dot2c_f32_bf16 v41, v78, v57
    v_dot2c_f32_bf16 v42, v79, v56
    v_dot2c_f32_bf16 v43, v79, v57
    s_waitcnt vmcnt(3)
    buffer_load_dwordx4 v[104:107], v2, s[8:11], s56 offen offset:3072 nt
    buffer_load_dwordx4 v[108:111], v2, s[8:11], s56 offen offset:3200 nt
    buffer_load_dwordx4 v[112:115], v2, s[8:11], s56 offen offset:3328 nt
    v_dot2c_f32_bf16 v20, v80, v58
    v_dot2c_f32_bf16 v21, v80, v59
    v_dot2c_f32_bf16 v22, v81, v58
    v_dot2c_f32_bf16 v23, v81, v59
    v_dot2c_f32_bf16 v24, v82, v58
    v_dot2c_f32_bf16 v25, v82, v59
    v_dot2c_f32_bf16 v26, v83, v58
    v_dot2c_f32_bf16 v27, v83, v59
    v_dot2c_f32_bf16 v28, v84, v58
    v_dot2c_f32_bf16 v29, v84, v59
    v_dot2c_f32_bf16 v30, v85, v58
    v_dot2c_f32_bf16 v31, v85, v59
    v_dot2c_f32_bf16 v32, v86, v58
    v_dot2c_f32_bf16 v33, v86, v59
    v_dot2c_f32_bf16 v34, v87, v58
    v_dot2c_f32_bf16 v35, v87, v59
    v_dot2c_f32_bf16 v36, v88, v58
    v_dot2c_f32_bf16 v37, v88, v59
    v_dot2c_f32_bf16 v38, v89, v58
    v_dot2c_f32_bf16 v39, v89, v59
    v_dot2c_f32_bf16 v40, v90, v58
    v_dot2c_f32_bf16 v41, v90, v59
    v_dot2c_f32_bf16 v42, v91, v58
    v_dot2c_f32_bf16 v43, v91, v59
    s_mov_b64 exec, 1
    ds_add_rtn_u32 v224, v223, v227 offset:12
    s_mov_b64 exec, -1
    s_waitcnt vmcnt(3)
    s_waitcnt lgkmcnt(0)
    v_readfirstlane_b32 s69, v224
    v_and_b32 v225, -4, v224
    v_add_u32 v225, 118604, v225
    s_and_b32 s78, s69, 3
    s_cmp_lt_u32 s69, 100
    s_cselect_b32 s78, 1, s78
    s_cmp_lg_u32 s78, 0
    s_cbranch_scc1 L_noclaimv
    v_mov_b32 v4, 1
    s_mov_b64 exec, 1
    buffer_atomic_add v4, v3, s[16:19], 0 offen offset:0 sc0 sc1
    s_mov_b64 exec, -1
L_noclaimv:
    buffer_load_dwordx4 v[68:71], v1, s[12:15], s56 offen offset:0 nt
    buffer_load_dwordx4 v[72:75], v1, s[12:15], s56 offen offset:128 nt
    buffer_load_dwordx4 v[76:79], v1, s[12:15], s56 offen offset:256 nt
    v_dot2c_f32_bf16 v20, v92, v60
    v_dot2c_f32_bf16 v21, v92, v61
    v_dot2c_f32_bf16 v22, v93, v60
    v_dot2c_f32_bf16 v23, v93, v61
    v_dot2c_f32_bf16 v24, v94, v60
    v_dot2c_f32_bf16 v25, v94, v61
    v_dot2c_f32_bf16 v26, v95, v60
    v_dot2c_f32_bf16 v27, v95, v61
    v_dot2c_f32_bf16 v28, v96, v60
    v_dot2c_f32_bf16 v29, v96, v61
    v_dot2c_f32_bf16 v30, v97, v60
    v_dot2c_f32_bf16 v31, v97, v61
    v_dot2c_f32_bf16 v32, v98, v60
    v_dot2c_f32_bf16 v33, v98, v61
    v_dot2c_f32_bf16 v34, v99, v60
    v_dot2c_f32_bf16 v35, v99, v61
    v_dot2c_f32_bf16 v36, v100, v60
    v_dot2c_f32_bf16 v37, v100, v61
    v_dot2c_f32_bf16 v38, v101, v60
    v_dot2c_f32_bf16 v39, v101, v61
    v_dot2c_f32_bf16 v40, v102, v60
    v_dot2c_f32_bf16 v41, v102, v61
    v_dot2c_f32_bf16 v42, v103, v60
    v_dot2c_f32_bf16 v43, v103, v61
    s_waitcnt vmcnt(4)
    s_cmp_eq_u32 s78, 0
    s_cbranch_scc1 L_k3v
    s_waitcnt vmcnt(3)
L_k3v:
    buffer_load_dwordx4 v[80:83], v1, s[12:15], s56 offen offset:3072 nt
    buffer_load_dwordx4 v[84:87], v1, s[12:15], s56 offen offset:3200 nt
    buffer_load_dwordx4 v[88:91], v1, s[12:15], s56 offen offset:3328 nt
    v_dot2c_f32_bf16 v20, v104, v62
    v_dot2c_f32_bf16 v21, v104, v63
    v_dot2c_f32_bf16 v22, v105, v62
    v_dot2c_f32_bf16 v23, v105, v63
    v_dot2c_f32_bf16 v24, v106, v62
    v_dot2c_f32_bf16 v25, v106, v63
    v_dot2c_f32_bf16 v26, v107, v62
    v_dot2c_f32_bf16 v27, v107, v63
    v_dot2c_f32_bf16 v28, v108, v62
    v_dot2c_f32_bf16 v29, v108, v63
    v_dot2c_f32_bf16 v30, v109, v62
    v_dot2c_f32_bf16 v31, v109, v63
    v_dot2c_f32_bf16 v32, v110, v62
    v_dot2c_f32_bf16 v33, v110, v63
    v_dot2c_f32_bf16 v34, v111, v62
    v_dot2c_f32_bf16 v35, v111, v63
    v_dot2c_f32_bf16 v36, v112, v62
    v_dot2c_f32_bf16 v37, v112, v63
    v_dot2c_f32_bf16 v38, v113, v62
    v_dot2c_f32_bf16 v39, v113, v63
    v_dot2c_f32_bf16 v40, v114, v62
    v_dot2c_f32_bf16 v41, v114, v63
    v_dot2c_f32_bf16 v42, v115, v62
    v_dot2c_f32_bf16 v43, v115, v63
    buffer_load_dwordx4 v[92:95], v2, s[12:15], s56 offen offset:0 nt
    buffer_load_dwordx4 v[96:99], v2, s[12:15], s56 offen offset:128 nt
    buffer_load_dwordx4 v[100:103], v2, s[12:15], s56 offen offset:256 nt
L_midv:
    v_lshlrev_b32 v52, 16, v214
    v_and_b32 v53, s70, v214
    v_lshlrev_b32 v54, 16, v215
    v_and_b32 v55, s70, v215
    v_max3_f32 v64, v52, v53, v54
    v_max_f32 v64, v64, v55
    v_mul_f32 v64, s71, v64
    v_max_f32 v64, v64, v6
    v_sub_f32 v66, v6, v64
    v_mov_b32 v6, v64
    v_fma_f32 v52, v52, s71, -v64
    v_fma_f32 v53, v53, s71, -v64
    v_fma_f32 v54, v54, s71, -v64
    v_fma_f32 v55, v55, s71, -v64
    v_exp_f32 v66, v66
    v_exp_f32 v52, v52
    v_exp_f32 v53, v53
    v_exp_f32 v54, v54
    v_exp_f32 v55, v55
    v_pk_mul_f32 v[20:21], v[20:21], v[66:67] op_sel_hi:[1,0]
    v_pk_mul_f32 v[22:23], v[22:23], v[66:67] op_sel_hi:[1,0]
    v_pk_mul_f32 v[24:25], v[24:25], v[66:67] op_sel_hi:[1,0]
    v_pk_mul_f32 v[26:27], v[26:27], v[66:67] op_sel_hi:[1,0]
    v_pk_mul_f32 v[28:29], v[28:29], v[66:67] op_sel_hi:[1,0]
    v_pk_mul_f32 v[30:31], v[30:31], v[66:67] op_sel_hi:[1,0]
    v_pk_mul_f32 v[32:33], v[32:33], v[66:67] op_sel_hi:[1,0]
    v_pk_mul_f32 v[34:35], v[34:35], v[66:67] op_sel_hi:[1,0]
    v_pk_mul_f32 v[36:37], v[36:37], v[66:67] op_sel_hi:[1,0]
    v_pk_mul_f32 v[38:39], v[38:39], v[66:67] op_sel_hi:[1,0]
    v_pk_mul_f32 v[40:41], v[40:41], v[66:67] op_sel_hi:[1,0]
    v_pk_mul_f32 v[42:43], v[42:43], v[66:67] op_sel_hi:[1,0]
    v_cvt_pk_bf16_f32 v56, v52, 0
    v_cvt_pk_bf16_f32 v58, v53, 0
    v_cvt_pk_bf16_f32 v60, v54, 0
    v_cvt_pk_bf16_f32 v62, v55, 0
    v_lshlrev_b32 v57, 16, v56
    v_lshlrev_b32 v59, 16, v58
    v_lshlrev_b32 v61, 16, v60
    v_lshlrev_b32 v63, 16, v62
    v_fma_f32 v7, v7, v66, v57
    v_add_f32 v64, v59, v61
    v_add_f32 v7, v7, v63
    v_add_f32 v7, v7, v64
    s_waitcnt vmcnt(6)
    s_cmp_lg_u32 s78, 0
    s_cbranch_scc1 L_nopubv
    s_mov_b64 exec, 1
    v_lshlrev_b32 v4, 2, v4
    v_add_u32 v4, 897, v4
    ds_write_b32 v225, v4
    s_mov_b64 exec, -1
L_nopubv:
    v_dot2c_f32_bf16 v20, v68, v56
    v_dot2c_f32_bf16 v21, v68, v57
    v_dot2c_f32_bf16 v22, v69, v56
    v_dot2c_f32_bf16 v23, v69, v57
    v_dot2c_f32_bf16 v24, v70, v56
    v_dot2c_f32_bf16 v25, v70, v57
    v_dot2c_f32_bf16 v26, v71, v56
    v_dot2c_f32_bf16 v27, v71, v57
    v_dot2c_f32_bf16 v28, v72, v56
    v_dot2c_f32_bf16 v29, v72, v57
    v_dot2c_f32_bf16 v30, v73, v56
    v_dot2c_f32_bf16 v31, v73, v57
    v_dot2c_f32_bf16 v32, v74, v56
    v_dot2c_f32_bf16 v33, v74, v57
    v_dot2c_f32_bf16 v34, v75, v56
    v_dot2c_f32_bf16 v35, v75, v57
    v_dot2c_f32_bf16 v36, v76, v56
    v_dot2c_f32_bf16 v37, v76, v57
    v_dot2c_f32_bf16 v38, v77, v56
    v_dot2c_f32_bf16 v39, v77, v57
    v_dot2c_f32_bf16 v40, v78, v56
    v_dot2c_f32_bf16 v41, v78, v57
    v_dot2c_f32_bf16 v42, v79, v56
    v_dot2c_f32_bf16 v43, v79, v57
    s_waitcnt vmcnt(3)
    buffer_load_dwordx4 v[104:107], v2, s[12:15], s56 offen offset:3072 nt
    buffer_load_dwordx4 v[108:111], v2, s[12:15], s56 offen offset:3200 nt
    buffer_load_dwordx4 v[112:115], v2, s[12:15], s56 offen offset:3328 nt
L_v1v:
    v_dot2c_f32_bf16 v20, v80, v58
    v_dot2c_f32_bf16 v21, v80, v59
    v_dot2c_f32_bf16 v22, v81, v58
    v_dot2c_f32_bf16 v23, v81, v59
    v_dot2c_f32_bf16 v24, v82, v58
    v_dot2c_f32_bf16 v25, v82, v59
    v_dot2c_f32_bf16 v26, v83, v58
    v_dot2c_f32_bf16 v27, v83, v59
    v_dot2c_f32_bf16 v28, v84, v58
    v_dot2c_f32_bf16 v29, v84, v59
    v_dot2c_f32_bf16 v30, v85, v58
    v_dot2c_f32_bf16 v31, v85, v59
    v_dot2c_f32_bf16 v32, v86, v58
    v_dot2c_f32_bf16 v33, v86, v59
    v_dot2c_f32_bf16 v34, v87, v58
    v_dot2c_f32_bf16 v35, v87, v59
    v_dot2c_f32_bf16 v36, v88, v58
    v_dot2c_f32_bf16 v37, v88, v59
    v_dot2c_f32_bf16 v38, v89, v58
    v_dot2c_f32_bf16 v39, v89, v59
    v_dot2c_f32_bf16 v40, v90, v58
    v_dot2c_f32_bf16 v41, v90, v59
    v_dot2c_f32_bf16 v42, v91, v58
    v_dot2c_f32_bf16 v43, v91, v59
    s_waitcnt vmcnt(3)
    s_mov_b64 exec, 1
    ds_read_b32 v226, v225
    s_mov_b64 exec, -1
    s_waitcnt lgkmcnt(0)
    v_readfirstlane_b32 s72, v226
    s_mov_b32 s6, 0
    s_nop 0
    s_cmp_eq_u32 s72, 0
    s_cbranch_scc1 L_sp0v
L_sp0vr:
    s_and_b32 s73, s69, 3
    s_add_u32 s72, s72, s73
    s_sub_u32 s72, s72, 1
    s_cmp_ge_u32 s72, 992
    s_cbranch_scc1 L_trans
    s_lshr_b32 s60, s72, 8
    s_and_b32 s72, s72, 255
    s_cmp_lt_u32 s60, 2
    s_cselect_b32 s30, 0, 0
    s_cselect_b32 s31, 8, 8
    s_cselect_b32 s32, 4, 5
    s_cselect_b32 s29, 0, 32
    s_lshl_b32 s31, s31, 4
    s_cmp_eq_u32 s60, 3
    s_cbranch_scc0 L_ph3
    s_mov_b32 s31, 64
    s_mov_b32 s29, 48
    s_cmp_lt_u32 s72, 128
    s_cbranch_scc1 L_ph3
    s_mov_b32 s28, 0
    s_mov_b64 s[8:9], s[24:25]
    s_mov_b64 s[12:13], s[26:27]
    s_branch L_phd3
L_ph3:
    s_sub_u32 s72, s72, s30
    s_cmp_ge_u32 s72, s31
    s_cselect_b64 s[8:9], s[26:27], s[24:25]
    s_cselect_b32 s28, 2, 1
    s_cselect_b32 s31, s31, 0
    s_sub_u32 s72, s72, s31
    s_add_u32 s12, s8, 12288
    s_addc_u32 s13, s9, 0
    s_lshr_b32 s31, s72, s32
    s_lshl2_add_u32 s29, s31, s29
    s_and_b32 s31, s72, 3
    s_add_u32 s29, s29, s31
    s_lshl1_add_u32 s72, s72, s30
L_phd3:
    s_add_u32 s72, s72, s79
    s_lshl_b32 s73, s60, 3
    s_lshr_b32 s73, 0xec007c00, s73
    s_add_u32 s72, s72, s73
    s_and_b32 s72, s72, 255
    s_mul_i32 s72, s72, 12288
    s_mul_i32 s73, s60, 100663296
    s_add_u32 s56, s58, s72
    s_add_u32 s56, s56, s73
    buffer_load_dwordx4 v[68:71], v1, s[8:11], s56 offen offset:0 nt
    buffer_load_dwordx4 v[72:75], v1, s[8:11], s56 offen offset:128 nt
    buffer_load_dwordx4 v[76:79], v1, s[8:11], s56 offen offset:256 nt
    v_dot2c_f32_bf16 v20, v92, v60
    v_dot2c_f32_bf16 v21, v92, v61
    v_dot2c_f32_bf16 v22, v93, v60
    v_dot2c_f32_bf16 v23, v93, v61
    v_dot2c_f32_bf16 v24, v94, v60
    v_dot2c_f32_bf16 v25, v94, v61
    v_dot2c_f32_bf16 v26, v95, v60
    v_dot2c_f32_bf16 v27, v95, v61
    v_dot2c_f32_bf16 v28, v96, v60
    v_dot2c_f32_bf16 v29, v96, v61
    v_dot2c_f32_bf16 v30, v97, v60
    v_dot2c_f32_bf16 v31, v97, v61
    v_dot2c_f32_bf16 v32, v98, v60
    v_dot2c_f32_bf16 v33, v98, v61
    v_dot2c_f32_bf16 v34, v99, v60
    v_dot2c_f32_bf16 v35, v99, v61
    v_dot2c_f32_bf16 v36, v100, v60
    v_dot2c_f32_bf16 v37, v100, v61
    v_dot2c_f32_bf16 v38, v101, v60
    v_dot2c_f32_bf16 v39, v101, v61
    v_dot2c_f32_bf16 v40, v102, v60
    v_dot2c_f32_bf16 v41, v102, v61
    v_dot2c_f32_bf16 v42, v103, v60
    v_dot2c_f32_bf16 v43, v103, v61
    s_waitcnt vmcnt(3)
    buffer_load_dwordx4 v[80:83], v1, s[8:11], s56 offen offset:3072 nt
    buffer_load_dwordx4 v[84:87], v1, s[8:11], s56 offen offset:3200 nt
    buffer_load_dwordx4 v[88:91], v1, s[8:11], s56 offen offset:3328 nt
    v_dot2c_f32_bf16 v20, v104, v62
    v_dot2c_f32_bf16 v21, v104, v63
    v_dot2c_f32_bf16 v22, v105, v62
    v_dot2c_f32_bf16 v23, v105, v63
    v_dot2c_f32_bf16 v24, v106, v62
    v_dot2c_f32_bf16 v25, v106, v63
    v_dot2c_f32_bf16 v26, v107, v62
    v_dot2c_f32_bf16 v27, v107, v63
    v_dot2c_f32_bf16 v28, v108, v62
    v_dot2c_f32_bf16 v29, v108, v63
    v_dot2c_f32_bf16 v30, v109, v62
    v_dot2c_f32_bf16 v31, v109, v63
    v_dot2c_f32_bf16 v32, v110, v62
    v_dot2c_f32_bf16 v33, v110, v63
    v_dot2c_f32_bf16 v34, v111, v62
    v_dot2c_f32_bf16 v35, v111, v63
    v_dot2c_f32_bf16 v36, v112, v62
    v_dot2c_f32_bf16 v37, v112, v63
    v_dot2c_f32_bf16 v38, v113, v62
    v_dot2c_f32_bf16 v39, v113, v63
    v_dot2c_f32_bf16 v40, v114, v62
    v_dot2c_f32_bf16 v41, v114, v63
    v_dot2c_f32_bf16 v42, v115, v62
    v_dot2c_f32_bf16 v43, v115, v63
    s_cmp_eq_u32 s60, s59
    s_cbranch_scc1 L_next
    s_branch L_flush
L_scs:
    ds_read_b32 v218, v217
    ds_read_b128 v[212:215], v216
    s_branch L_scw
L_ktrans:
    s_waitcnt vmcnt(0)
    v_dot2_f32_bf16 v48, v92, v8, 0
    v_dot2_f32_bf16 v49, v93, v9, 0
    v_dot2_f32_bf16 v48, v94, v10, v48
    v_dot2_f32_bf16 v49, v95, v11, v49
    v_dot2_f32_bf16 v48, v96, v12, v48
    v_dot2_f32_bf16 v49, v97, v13, v49
    v_dot2_f32_bf16 v48, v98, v14, v48
    v_dot2_f32_bf16 v49, v99, v15, v49
    v_dot2_f32_bf16 v48, v100, v16, v48
    v_dot2_f32_bf16 v49, v101, v17, v49
    v_dot2_f32_bf16 v48, v102, v18, v48
    v_dot2_f32_bf16 v49, v103, v19, v49
    v_dot2_f32_bf16 v50, v104, v8, 0
    v_dot2_f32_bf16 v51, v105, v9, 0
    v_dot2_f32_bf16 v50, v106, v10, v50
    v_dot2_f32_bf16 v51, v107, v11, v51
    v_dot2_f32_bf16 v50, v108, v12, v50
    v_dot2_f32_bf16 v51, v109, v13, v51
    v_dot2_f32_bf16 v50, v110, v14, v50
    v_dot2_f32_bf16 v51, v111, v15, v51
    v_dot2_f32_bf16 v50, v112, v16, v50
    v_dot2_f32_bf16 v51, v113, v17, v51
    v_dot2_f32_bf16 v50, v114, v18, v50
    v_dot2_f32_bf16 v51, v115, v19, v51
    v_add_f32 v52, v44, v45
    v_add_f32 v53, v46, v47
    v_add_f32 v54, v48, v49
    v_add_f32 v55, v50, v51
    v_add_f32_dpp v52, v52, v52 quad_perm:[1,0,3,2] row_mask:0xf bank_mask:0xf
    v_add_f32_dpp v53, v53, v53 quad_perm:[1,0,3,2] row_mask:0xf bank_mask:0xf
    v_add_f32_dpp v54, v54, v54 quad_perm:[1,0,3,2] row_mask:0xf bank_mask:0xf
    v_add_f32_dpp v55, v55, v55 quad_perm:[1,0,3,2] row_mask:0xf bank_mask:0xf
    v_add_f32_dpp v52, v52, v52 quad_perm:[2,3,0,1] row_mask:0xf bank_mask:0xf
    v_add_f32_dpp v53, v53, v53 quad_perm:[2,3,0,1] row_mask:0xf bank_mask:0xf
    v_add_f32_dpp v54, v54, v54 quad_perm:[2,3,0,1] row_mask:0xf bank_mask:0xf
    v_add_f32_dpp v55, v55, v55 quad_perm:[2,3,0,1] row_mask:0xf bank_mask:0xf
    v_add_f32_dpp v52, v52, v52 row_half_mirror row_mask:0xf bank_mask:0xf
    v_add_f32_dpp v53, v53, v53 row_half_mirror row_mask:0xf bank_mask:0xf
    v_add_f32_dpp v54, v54, v54 row_half_mirror row_mask:0xf bank_mask:0xf
    v_add_f32_dpp v55, v55, v55 row_half_mirror row_mask:0xf bank_mask:0xf
    v_cvt_pk_bf16_f32 v214, v52, v53
    v_cvt_pk_bf16_f32 v215, v54, v55
    v_lshlrev_b32 v52, 16, v214
    v_and_b32 v53, s70, v214
    v_lshlrev_b32 v54, 16, v215
    v_and_b32 v55, s70, v215
    v_mul_f32 v52, 0x3d93cd3a, v52
    v_mul_f32 v53, 0x3d93cd3a, v53
    v_mul_f32 v54, 0x3d93cd3a, v54
    v_mul_f32 v55, 0x3d93cd3a, v55
    v_cvt_pk_bf16_f32 v214, v52, v53
    v_cvt_pk_bf16_f32 v215, v54, v55
    s_mov_b32 exec_lo, 0x01010101
    s_mov_b32 exec_hi, 0x01010101
    ds_write_b128 v216, v[212:215]
    s_mov_b64 exec, 1
    ds_write_b32 v217, v227
    s_mov_b64 exec, -1
    v_mov_b32 v60, 0
    v_mov_b32 v61, 0
    v_mov_b32 v62, 0
    v_mov_b32 v63, 0
    s_branch L_trans
L_item:
    s_waitcnt vmcnt(3)
    buffer_load_dwordx4 v[92:95], v2, s[8:11], s56 offen offset:0 nt
    buffer_load_dwordx4 v[96:99], v2, s[8:11], s56 offen offset:128 nt
    buffer_load_dwordx4 v[100:103], v2, s[8:11], s56 offen offset:256 nt
    v_dot2_f32_bf16 v44, v68, v8, 0
    v_dot2_f32_bf16 v45, v69, v9, 0
    v_dot2_f32_bf16 v44, v70, v10, v44
    v_dot2_f32_bf16 v45, v71, v11, v45
    v_dot2_f32_bf16 v44, v72, v12, v44
    v_dot2_f32_bf16 v45, v73, v13, v45
    v_dot2_f32_bf16 v44, v74, v14, v44
    v_dot2_f32_bf16 v45, v75, v15, v45
    v_dot2_f32_bf16 v44, v76, v16, v44
    v_dot2_f32_bf16 v45, v77, v17, v45
    v_dot2_f32_bf16 v44, v78, v18, v44
    v_dot2_f32_bf16 v45, v79, v19, v45
    s_waitcnt vmcnt(3)
    buffer_load_dwordx4 v[104:107], v2, s[8:11], s56 offen offset:3072 nt
    buffer_load_dwordx4 v[108:111], v2, s[8:11], s56 offen offset:3200 nt
    buffer_load_dwordx4 v[112:115], v2, s[8:11], s56 offen offset:3328 nt
    v_dot2_f32_bf16 v46, v80, v8, 0
    v_dot2_f32_bf16 v47, v81, v9, 0
    v_dot2_f32_bf16 v46, v82, v10, v46
    v_dot2_f32_bf16 v47, v83, v11, v47
    v_dot2_f32_bf16 v46, v84, v12, v46
    v_dot2_f32_bf16 v47, v85, v13, v47
    v_dot2_f32_bf16 v46, v86, v14, v46
    v_dot2_f32_bf16 v47, v87, v15, v47
    v_dot2_f32_bf16 v46, v88, v16, v46
    v_dot2_f32_bf16 v47, v89, v17, v47
    v_dot2_f32_bf16 v46, v90, v18, v46
    v_dot2_f32_bf16 v47, v91, v19, v47
    s_mov_b64 exec, 1
    ds_add_rtn_u32 v224, v223, v227 offset:12
    s_mov_b64 exec, -1
    s_waitcnt vmcnt(3)
    s_waitcnt lgkmcnt(0)
    v_readfirstlane_b32 s69, v224
    v_and_b32 v225, -4, v224
    v_add_u32 v225, 118604, v225
    s_and_b32 s78, s69, 3
    s_cmp_lt_u32 s69, 100
    s_cselect_b32 s78, 1, s78
    s_cmp_lg_u32 s78, 0
    s_cbranch_scc1 L_noclaim
    v_mov_b32 v4, 1
    s_mov_b64 exec, 1
    buffer_atomic_add v4, v3, s[16:19], 0 offen offset:0 sc0 sc1
    s_mov_b64 exec, -1
L_noclaim:
    buffer_load_dwordx4 v[68:71], v1, s[12:15], s56 offen offset:0 nt
    buffer_load_dwordx4 v[72:75], v1, s[12:15], s56 offen offset:128 nt
    buffer_load_dwordx4 v[76:79], v1, s[12:15], s56 offen offset:256 nt
    v_dot2_f32_bf16 v48, v92, v8, 0
    v_dot2_f32_bf16 v49, v93, v9, 0
    v_dot2_f32_bf16 v48, v94, v10, v48
    v_dot2_f32_bf16 v49, v95, v11, v49
    v_dot2_f32_bf16 v48, v96, v12, v48
    v_dot2_f32_bf16 v49, v97, v13, v49
    v_dot2_f32_bf16 v48, v98, v14, v48
    v_dot2_f32_bf16 v49, v99, v15, v49
    v_dot2_f32_bf16 v48, v100, v16, v48
    v_dot2_f32_bf16 v49, v101, v17, v49
    v_dot2_f32_bf16 v48, v102, v18, v48
    v_dot2_f32_bf16 v49, v103, v19, v49
    s_waitcnt vmcnt(4)
    s_cmp_eq_u32 s78, 0
    s_cbranch_scc1 L_k3
    s_waitcnt vmcnt(3)
L_k3:
    buffer_load_dwordx4 v[80:83], v1, s[12:15], s56 offen offset:3072 nt
    buffer_load_dwordx4 v[84:87], v1, s[12:15], s56 offen offset:3200 nt
    buffer_load_dwordx4 v[88:91], v1, s[12:15], s56 offen offset:3328 nt
    v_dot2_f32_bf16 v50, v104, v8, 0
    v_dot2_f32_bf16 v51, v105, v9, 0
    v_dot2_f32_bf16 v50, v106, v10, v50
    v_dot2_f32_bf16 v51, v107, v11, v51
    v_dot2_f32_bf16 v50, v108, v12, v50
    v_dot2_f32_bf16 v51, v109, v13, v51
    v_dot2_f32_bf16 v50, v110, v14, v50
    v_dot2_f32_bf16 v51, v111, v15, v51
    v_dot2_f32_bf16 v50, v112, v16, v50
    v_dot2_f32_bf16 v51, v113, v17, v51
    v_dot2_f32_bf16 v50, v114, v18, v50
    v_dot2_f32_bf16 v51, v115, v19, v51
    buffer_load_dwordx4 v[92:95], v2, s[12:15], s56 offen offset:0 nt
    buffer_load_dwordx4 v[96:99], v2, s[12:15], s56 offen offset:128 nt
    buffer_load_dwordx4 v[100:103], v2, s[12:15], s56 offen offset:256 nt
L_mid:
    v_add_f32 v52, v44, v45
    v_add_f32 v53, v46, v47
    v_add_f32 v54, v48, v49
    v_add_f32 v55, v50, v51
    v_add_f32_dpp v52, v52, v52 quad_perm:[1,0,3,2] row_mask:0xf bank_mask:0xf
    v_add_f32_dpp v53, v53, v53 quad_perm:[1,0,3,2] row_mask:0xf bank_mask:0xf
    v_add_f32_dpp v54, v54, v54 quad_perm:[1,0,3,2] row_mask:0xf bank_mask:0xf
    v_add_f32_dpp v55, v55, v55 quad_perm:[1,0,3,2] row_mask:0xf bank_mask:0xf
    v_add_f32_dpp v52, v52, v52 quad_perm:[2,3,0,1] row_mask:0xf bank_mask:0xf
    v_add_f32_dpp v53, v53, v53 quad_perm:[2,3,0,1] row_mask:0xf bank_mask:0xf
    v_add_f32_dpp v54, v54, v54 quad_perm:[2,3,0,1] row_mask:0xf bank_mask:0xf
    v_add_f32_dpp v55, v55, v55 quad_perm:[2,3,0,1] row_mask:0xf bank_mask:0xf
    v_add_f32_dpp v52, v52, v52 row_half_mirror row_mask:0xf bank_mask:0xf
    v_add_f32_dpp v53, v53, v53 row_half_mirror row_mask:0xf bank_mask:0xf
    v_add_f32_dpp v54, v54, v54 row_half_mirror row_mask:0xf bank_mask:0xf
    v_add_f32_dpp v55, v55, v55 row_half_mirror row_mask:0xf bank_mask:0xf
    v_cvt_pk_bf16_f32 v64, v52, v53
    v_cvt_pk_bf16_f32 v65, v54, v55
    v_lshlrev_b32 v52, 16, v64
    v_and_b32 v53, s70, v64
    v_lshlrev_b32 v54, 16, v65
    v_and_b32 v55, s70, v65
    v_mul_f32 v52, 0x3d93cd3a, v52
    v_mul_f32 v53, 0x3d93cd3a, v53
    v_mul_f32 v54, 0x3d93cd3a, v54
    v_mul_f32 v55, 0x3d93cd3a, v55
    v_cvt_pk_bf16_f32 v64, v52, v53
    v_cvt_pk_bf16_f32 v65, v54, v55
    v_lshlrev_b32 v52, 16, v64
    v_and_b32 v53, s70, v64
    v_lshlrev_b32 v54, 16, v65
    v_and_b32 v55, s70, v65
    v_max3_f32 v64, v52, v53, v54
    v_max_f32 v64, v64, v55
    v_mul_f32 v64, s71, v64
    v_max_f32 v64, v64, v6
    v_sub_f32 v66, v6, v64
    v_mov_b32 v6, v64
    v_fma_f32 v52, v52, s71, -v64
    v_fma_f32 v53, v53, s71, -v64
    v_fma_f32 v54, v54, s71, -v64
    v_fma_f32 v55, v55, s71, -v64
    v_exp_f32 v66, v66
    v_exp_f32 v52, v52
    v_exp_f32 v53, v53
    v_exp_f32 v54, v54
    v_exp_f32 v55, v55
    v_pk_mul_f32 v[20:21], v[20:21], v[66:67] op_sel_hi:[1,0]
    v_pk_mul_f32 v[22:23], v[22:23], v[66:67] op_sel_hi:[1,0]
    v_pk_mul_f32 v[24:25], v[24:25], v[66:67] op_sel_hi:[1,0]
    v_pk_mul_f32 v[26:27], v[26:27], v[66:67] op_sel_hi:[1,0]
    v_pk_mul_f32 v[28:29], v[28:29], v[66:67] op_sel_hi:[1,0]
    v_pk_mul_f32 v[30:31], v[30:31], v[66:67] op_sel_hi:[1,0]
    v_pk_mul_f32 v[32:33], v[32:33], v[66:67] op_sel_hi:[1,0]
    v_pk_mul_f32 v[34:35], v[34:35], v[66:67] op_sel_hi:[1,0]
    v_pk_mul_f32 v[36:37], v[36:37], v[66:67] op_sel_hi:[1,0]
    v_pk_mul_f32 v[38:39], v[38:39], v[66:67] op_sel_hi:[1,0]
    v_pk_mul_f32 v[40:41], v[40:41], v[66:67] op_sel_hi:[1,0]
    v_pk_mul_f32 v[42:43], v[42:43], v[66:67] op_sel_hi:[1,0]
    v_cvt_pk_bf16_f32 v56, v52, 0
    v_cvt_pk_bf16_f32 v58, v53, 0
    v_cvt_pk_bf16_f32 v60, v54, 0
    v_cvt_pk_bf16_f32 v62, v55, 0
    v_lshlrev_b32 v57, 16, v56
    v_lshlrev_b32 v59, 16, v58
    v_lshlrev_b32 v61, 16, v60
    v_lshlrev_b32 v63, 16, v62
    v_fma_f32 v7, v7, v66, v57
    v_add_f32 v64, v59, v61
    v_add_f32 v7, v7, v63
    v_add_f32 v7, v7, v64
    s_waitcnt vmcnt(6)
    s_cmp_lg_u32 s78, 0
    s_cbranch_scc1 L_nopub
    s_mov_b64 exec, 1
    v_lshlrev_b32 v4, 2, v4
    v_add_u32 v4, 897, v4
    ds_write_b32 v225, v4
    s_mov_b64 exec, -1
L_nopub:
    v_dot2c_f32_bf16 v20, v68, v56
    v_dot2c_f32_bf16 v21, v68, v57
    v_dot2c_f32_bf16 v22, v69, v56
    v_dot2c_f32_bf16 v23, v69, v57
    v_dot2c_f32_bf16 v24, v70, v56
    v_dot2c_f32_bf16 v25, v70, v57
    v_dot2c_f32_bf16 v26, v71, v56
    v_dot2c_f32_bf16 v27, v71, v57
    v_dot2c_f32_bf16 v28, v72, v56
    v_dot2c_f32_bf16 v29, v72, v57
    v_dot2c_f32_bf16 v30, v73, v56
    v_dot2c_f32_bf16 v31, v73, v57
    v_dot2c_f32_bf16 v32, v74, v56
    v_dot2c_f32_bf16 v33, v74, v57
    v_dot2c_f32_bf16 v34, v75, v56
    v_dot2c_f32_bf16 v35, v75, v57
    v_dot2c_f32_bf16 v36, v76, v56
    v_dot2c_f32_bf16 v37, v76, v57
    v_dot2c_f32_bf16 v38, v77, v56
    v_dot2c_f32_bf16 v39, v77, v57
    v_dot2c_f32_bf16 v40, v78, v56
    v_dot2c_f32_bf16 v41, v78, v57
    v_dot2c_f32_bf16 v42, v79, v56
    v_dot2c_f32_bf16 v43, v79, v57
    s_waitcnt vmcnt(3)
    buffer_load_dwordx4 v[104:107], v2, s[12:15], s56 offen offset:3072 nt
    buffer_load_dwordx4 v[108:111], v2, s[12:15], s56 offen offset:3200 nt
    buffer_load_dwordx4 v[112:115], v2, s[12:15], s56 offen offset:3328 nt
L_v1:
    v_dot2c_f32_bf16 v20, v80, v58
    v_dot2c_f32_bf16 v21, v80, v59
    v_dot2c_f32_bf16 v22, v81, v58
    v_dot2c_f32_bf16 v23, v81, v59
    v_dot2c_f32_bf16 v24, v82, v58
    v_dot2c_f32_bf16 v25, v82, v59
    v_dot2c_f32_bf16 v26, v83, v58
    v_dot2c_f32_bf16 v27, v83, v59
    v_dot2c_f32_bf16 v28, v84, v58
    v_dot2c_f32_bf16 v29, v84, v59
    v_dot2c_f32_bf16 v30, v85, v58
    v_dot2c_f32_bf16 v31, v85, v59
    v_dot2c_f32_bf16 v32, v86, v58
    v_dot2c_f32_bf16 v33, v86, v59
    v_dot2c_f32_bf16 v34, v87, v58
    v_dot2c_f32_bf16 v35, v87, v59
    v_dot2c_f32_bf16 v36, v88, v58
    v_dot2c_f32_bf16 v37, v88, v59
    v_dot2c_f32_bf16 v38, v89, v58
    v_dot2c_f32_bf16 v39, v89, v59
    v_dot2c_f32_bf16 v40, v90, v58
    v_dot2c_f32_bf16 v41, v90, v59
    v_dot2c_f32_bf16 v42, v91, v58
    v_dot2c_f32_bf16 v43, v91, v59
    s_waitcnt vmcnt(3)
    s_mov_b64 exec, 1
    ds_read_b32 v226, v225
    s_mov_b64 exec, -1
    s_waitcnt lgkmcnt(0)
    v_readfirstlane_b32 s72, v226
    s_mov_b32 s6, 0
    s_nop 0
    s_cmp_eq_u32 s72, 0
    s_cbranch_scc1 L_sp0
L_sp0r:
    s_and_b32 s73, s69, 3
    s_add_u32 s72, s72, s73
    s_sub_u32 s72, s72, 1
    s_cmp_ge_u32 s72, 992
    s_cbranch_scc1 L_trans
    s_lshr_b32 s60, s72, 8
    s_and_b32 s72, s72, 255
    s_cmp_lt_u32 s60, 2
    s_cselect_b32 s30, 0, 0
    s_cselect_b32 s31, 8, 8
    s_cselect_b32 s32, 4, 5
    s_cselect_b32 s29, 0, 32
    s_lshl_b32 s31, s31, 4
    s_cmp_eq_u32 s60, 3
    s_cbranch_scc0 L_ph4
    s_mov_b32 s31, 64
    s_mov_b32 s29, 48
    s_cmp_lt_u32 s72, 128
    s_cbranch_scc1 L_ph4
    s_mov_b32 s28, 0
    s_mov_b64 s[8:9], s[24:25]
    s_mov_b64 s[12:13], s[26:27]
    s_branch L_phd4
L_ph4:
    s_sub_u32 s72, s72, s30
    s_cmp_ge_u32 s72, s31
    s_cselect_b64 s[8:9], s[26:27], s[24:25]
    s_cselect_b32 s28, 2, 1
    s_cselect_b32 s31, s31, 0
    s_sub_u32 s72, s72, s31
    s_add_u32 s12, s8, 12288
    s_addc_u32 s13, s9, 0
    s_lshr_b32 s31, s72, s32
    s_lshl2_add_u32 s29, s31, s29
    s_and_b32 s31, s72, 3
    s_add_u32 s29, s29, s31
    s_lshl1_add_u32 s72, s72, s30
L_phd4:
    s_add_u32 s72, s72, s79
    s_lshl_b32 s73, s60, 3
    s_lshr_b32 s73, 0xec007c00, s73
    s_add_u32 s72, s72, s73
    s_and_b32 s72, s72, 255
    s_mul_i32 s72, s72, 12288
    s_mul_i32 s73, s60, 100663296
    s_add_u32 s56, s58, s72
    s_add_u32 s56, s56, s73
    buffer_load_dwordx4 v[68:71], v1, s[8:11], s56 offen offset:0 nt
    buffer_load_dwordx4 v[72:75], v1, s[8:11], s56 offen offset:128 nt
    buffer_load_dwordx4 v[76:79], v1, s[8:11], s56 offen offset:256 nt
    v_dot2c_f32_bf16 v20, v92, v60
    v_dot2c_f32_bf16 v21, v92, v61
    v_dot2c_f32_bf16 v22, v93, v60
    v_dot2c_f32_bf16 v23, v93, v61
    v_dot2c_f32_bf16 v24, v94, v60
    v_dot2c_f32_bf16 v25, v94, v61
    v_dot2c_f32_bf16 v26, v95, v60
    v_dot2c_f32_bf16 v27, v95, v61
    v_dot2c_f32_bf16 v28, v96, v60
    v_dot2c_f32_bf16 v29, v96, v61
    v_dot2c_f32_bf16 v30, v97, v60
    v_dot2c_f32_bf16 v31, v97, v61
    v_dot2c_f32_bf16 v32, v98, v60
    v_dot2c_f32_bf16 v33, v98, v61
    v_dot2c_f32_bf16 v34, v99, v60
    v_dot2c_f32_bf16 v35, v99, v61
    v_dot2c_f32_bf16 v36, v100, v60
    v_dot2c_f32_bf16 v37, v100, v61
    v_dot2c_f32_bf16 v38, v101, v60
    v_dot2c_f32_bf16 v39, v101, v61
    v_dot2c_f32_bf16 v40, v102, v60
    v_dot2c_f32_bf16 v41, v102, v61
    v_dot2c_f32_bf16 v42, v103, v60
    v_dot2c_f32_bf16 v43, v103, v61
    s_waitcnt vmcnt(3)
    buffer_load_dwordx4 v[80:83], v1, s[8:11], s56 offen offset:3072 nt
    buffer_load_dwordx4 v[84:87], v1, s[8:11], s56 offen offset:3200 nt
    buffer_load_dwordx4 v[88:91], v1, s[8:11], s56 offen offset:3328 nt
    v_dot2c_f32_bf16 v20, v104, v62
    v_dot2c_f32_bf16 v21, v104, v63
    v_dot2c_f32_bf16 v22, v105, v62
    v_dot2c_f32_bf16 v23, v105, v63
    v_dot2c_f32_bf16 v24, v106, v62
    v_dot2c_f32_bf16 v25, v106, v63
    v_dot2c_f32_bf16 v26, v107, v62
    v_dot2c_f32_bf16 v27, v107, v63
    v_dot2c_f32_bf16 v28, v108, v62
    v_dot2c_f32_bf16 v29, v108, v63
    v_dot2c_f32_bf16 v30, v109, v62
    v_dot2c_f32_bf16 v31, v109, v63
    v_dot2c_f32_bf16 v32, v110, v62
    v_dot2c_f32_bf16 v33, v110, v63
    v_dot2c_f32_bf16 v34, v111, v62
    v_dot2c_f32_bf16 v35, v111, v63
    v_dot2c_f32_bf16 v36, v112, v62
    v_dot2c_f32_bf16 v37, v112, v63
    v_dot2c_f32_bf16 v38, v113, v62
    v_dot2c_f32_bf16 v39, v113, v63
    v_dot2c_f32_bf16 v40, v114, v62
    v_dot2c_f32_bf16 v41, v114, v63
    v_dot2c_f32_bf16 v42, v115, v62
    v_dot2c_f32_bf16 v43, v115, v63
    s_cmp_eq_u32 s60, s59
    s_cbranch_scc1 L_item
L_flush:
    v_mov_b32 v64, v6
    v_and_b32 v48, 7, v0
    v_lshlrev_b32 v48, 5, v48
    v_lshrrev_b32 v53, 4, v0
    v_lshl_add_u32 v48, v53, 3, v48
    v_add_u32 v48, s61, v48
    v_mov_b32 v53, s61
    v_max_f32_dpp v64, v64, v64 row_ror:8 row_mask:0xf bank_mask:0xf
    v_mov_b32 v67, v64
    s_nop 1
    v_permlane16_swap_b32 v64, v67
    v_max_f32 v64, v64, v67
    v_mov_b32 v67, v64
    s_nop 1
    v_permlane32_swap_b32 v64, v67
    v_max_f32 v64, v64, v67
    v_sub_f32 v66, v6, v64
    v_exp_f32 v66, v66
    v_mov_b32 v6, v64
    v_mul_f32 v7, v7, v66
    v_pk_mul_f32 v[20:21], v[20:21], v[66:67] op_sel_hi:[1,0]
    v_pk_mul_f32 v[22:23], v[22:23], v[66:67] op_sel_hi:[1,0]
    v_pk_mul_f32 v[24:25], v[24:25], v[66:67] op_sel_hi:[1,0]
    v_pk_mul_f32 v[26:27], v[26:27], v[66:67] op_sel_hi:[1,0]
    v_pk_mul_f32 v[28:29], v[28:29], v[66:67] op_sel_hi:[1,0]
    v_pk_mul_f32 v[30:31], v[30:31], v[66:67] op_sel_hi:[1,0]
    v_pk_mul_f32 v[32:33], v[32:33], v[66:67] op_sel_hi:[1,0]
    v_pk_mul_f32 v[34:35], v[34:35], v[66:67] op_sel_hi:[1,0]
    v_pk_mul_f32 v[36:37], v[36:37], v[66:67] op_sel_hi:[1,0]
    v_pk_mul_f32 v[38:39], v[38:39], v[66:67] op_sel_hi:[1,0]
    v_pk_mul_f32 v[40:41], v[40:41], v[66:67] op_sel_hi:[1,0]
    v_pk_mul_f32 v[42:43], v[42:43], v[66:67] op_sel_hi:[1,0]
L_flush2:
    v_mov_b32 v67, v7
    v_permlane16_swap_b32 v20, v22
    v_permlane16_swap_b32 v21, v23
    v_permlane16_swap_b32 v24, v26
    v_permlane16_swap_b32 v25, v27
    v_permlane16_swap_b32 v28, v30
    v_permlane16_swap_b32 v29, v31
    v_permlane16_swap_b32 v32, v34
    v_permlane16_swap_b32 v33, v35
    v_permlane16_swap_b32 v36, v38
    v_permlane16_swap_b32 v37, v39
    v_permlane16_swap_b32 v40, v42
    v_permlane16_swap_b32 v41, v43
    v_permlane16_swap_b32 v7, v67
    v_add_f32 v7, v7, v67
    v_pk_add_f32 v[20:21], v[20:21], v[22:23]
    v_pk_add_f32 v[24:25], v[24:25], v[26:27]
    v_pk_add_f32 v[28:29], v[28:29], v[30:31]
    v_pk_add_f32 v[32:33], v[32:33], v[34:35]
    v_pk_add_f32 v[36:37], v[36:37], v[38:39]
    v_pk_add_f32 v[40:41], v[40:41], v[42:43]
    v_mov_b32 v67, v7
    v_permlane32_swap_b32 v20, v24
    v_permlane32_swap_b32 v21, v25
    v_permlane32_swap_b32 v28, v32
    v_permlane32_swap_b32 v29, v33
    v_permlane32_swap_b32 v36, v40
    v_permlane32_swap_b32 v37, v41
    v_permlane32_swap_b32 v7, v67
    v_add_f32 v7, v7, v67
    v_pk_add_f32 v[20:21], v[20:21], v[24:25]
    v_pk_add_f32 v[28:29], v[28:29], v[32:33]
    v_pk_add_f32 v[36:37], v[36:37], v[40:41]
    v_add_f32_dpp v7, v7, v7 row_ror:8 row_mask:0xf bank_mask:0xf
    v_add_f32_dpp v20, v20, v20 row_ror:8 row_mask:0xf bank_mask:0xf
    v_add_f32_dpp v21, v21, v21 row_ror:8 row_mask:0xf bank_mask:0xf
    v_add_f32_dpp v28, v28, v28 row_ror:8 row_mask:0xf bank_mask:0xf
    v_add_f32_dpp v29, v29, v29 row_ror:8 row_mask:0xf bank_mask:0xf
    v_add_f32_dpp v36, v36, v36 row_ror:8 row_mask:0xf bank_mask:0xf
    v_add_f32_dpp v37, v37, v37 row_ror:8 row_mask:0xf bank_mask:0xf
    ds_write_b64 v48, v[20:21] offset:0
    ds_write_b64 v48, v[28:29] offset:256
    ds_write_b64 v48, v[36:37] offset:512
    s_mov_b64 exec, 1
    ds_write_b64 v53, v[6:7] offset:768
    ds_add_rtn_u32 v56, v222, v227 offset:16
    s_mov_b64 exec, -1
    s_cmp_lg_u32 s59, 3
    s_cbranch_scc1 L_nos1
L_s1:
    ds_read_b64 v[10:11], v47 offset:768
    ds_read_b64 v[12:13], v47 offset:3904
    ds_read_b64 v[14:15], v47 offset:7040
    ds_read_b64 v[16:17], v47 offset:10176
    ds_read_b128 v[20:23], v46 offset:0
    ds_read_b64 v[36:37], v51 offset:512
    ds_read_b128 v[24:27], v46 offset:3136
    ds_read_b64 v[38:39], v51 offset:3648
    ds_read_b128 v[28:31], v46 offset:6272
    ds_read_b64 v[40:41], v51 offset:6784
    ds_read_b128 v[32:35], v46 offset:9408
    ds_read_b64 v[42:43], v51 offset:9920
    s_waitcnt lgkmcnt(8)
    v_cmp_ne_u32 vcc, 3, v56
    s_bitcmp1_b32 vcc_lo, 0
    s_cbranch_scc1 L_fin
    v_max3_f32 v18, v10, v12, v14
    v_max_f32 v18, v18, v16
    v_sub_f32 v10, v10, v18
    v_sub_f32 v12, v12, v18
    v_sub_f32 v14, v14, v18
    v_sub_f32 v16, v16, v18
    v_exp_f32 v10, v10
    v_exp_f32 v12, v12
    v_exp_f32 v14, v14
    v_exp_f32 v16, v16
    v_mul_f32 v19, v10, v11
    v_fmac_f32 v19, v12, v13
    v_fmac_f32 v19, v14, v15
    v_fmac_f32 v19, v16, v17
    v_max_f32 v19, 0x0da24260, v19
    v_rcp_f32 v44, v19
    v_log_f32 v19, v19
    s_waitcnt lgkmcnt(6)
    v_pk_mul_f32 v[20:21], v[20:21], v[10:11] op_sel_hi:[1,0]
    v_pk_mul_f32 v[22:23], v[22:23], v[10:11] op_sel_hi:[1,0]
    v_pk_mul_f32 v[36:37], v[36:37], v[10:11] op_sel_hi:[1,0]
    s_waitcnt lgkmcnt(4)
    v_pk_fma_f32 v[20:21], v[24:25], v[12:13], v[20:21] op_sel_hi:[1,0,1]
    v_pk_fma_f32 v[22:23], v[26:27], v[12:13], v[22:23] op_sel_hi:[1,0,1]
    v_pk_fma_f32 v[36:37], v[38:39], v[12:13], v[36:37] op_sel_hi:[1,0,1]
    s_waitcnt lgkmcnt(2)
    v_pk_fma_f32 v[20:21], v[28:29], v[14:15], v[20:21] op_sel_hi:[1,0,1]
    v_pk_fma_f32 v[22:23], v[30:31], v[14:15], v[22:23] op_sel_hi:[1,0,1]
    v_pk_fma_f32 v[36:37], v[40:41], v[14:15], v[36:37] op_sel_hi:[1,0,1]
    s_waitcnt lgkmcnt(0)
    v_pk_fma_f32 v[20:21], v[32:33], v[16:17], v[20:21] op_sel_hi:[1,0,1]
    v_pk_fma_f32 v[22:23], v[34:35], v[16:17], v[22:23] op_sel_hi:[1,0,1]
    v_pk_fma_f32 v[36:37], v[42:43], v[16:17], v[36:37] op_sel_hi:[1,0,1]
    v_add_f32 v18, v18, v19
    v_pk_mul_f32 v[20:21], v[20:21], v[44:45] op_sel_hi:[1,0]
    v_pk_mul_f32 v[22:23], v[22:23], v[44:45] op_sel_hi:[1,0]
    v_pk_mul_f32 v[36:37], v[36:37], v[44:45] op_sel_hi:[1,0]
    v_lshlrev_b32 v18, v50, v18
    v_bfi_b32 v59, v55, v49, v18
    v_cvt_pk_bf16_f32 v56, v20, v21
    v_cvt_pk_bf16_f32 v57, v22, v23
    v_cvt_pk_bf16_f32 v58, v36, v37
    s_mov_b32 exec_hi, 0
    buffer_store_dwordx4 v[56:59], v54, s[16:19], s83 offen sc1
    s_mov_b32 exec_hi, -1
    s_cmp_ge_u32 s3, 4
    s_cbranch_scc1 L_fin
    s_cmp_eq_u32 s79, 1
    s_cbranch_scc1 L_pre4
    s_branch L_disp
L_nos1:
    s_cmp_eq_u32 s59, 0
    s_cselect_b32 s72, 2, 1
    s_add_u32 s59, s59, s72
    s_mul_i32 s72, s72, 384
    s_waitcnt lgkmcnt(0)
    s_add_u32 s61, s61, 784
    v_add_u32 v5, s72, v5
    v_add_u32 v222, 4, v222
    v_mov_b32 v20, 0
    v_mov_b32 v21, 0
    v_mov_b32 v22, 0
    v_mov_b32 v23, 0
    v_mov_b32 v24, 0
    v_mov_b32 v25, 0
    v_mov_b32 v26, 0
    v_mov_b32 v27, 0
    v_mov_b32 v28, 0
    v_mov_b32 v29, 0
    v_mov_b32 v30, 0
    v_mov_b32 v31, 0
    v_mov_b32 v32, 0
    v_mov_b32 v33, 0
    v_mov_b32 v34, 0
    v_mov_b32 v35, 0
    v_mov_b32 v36, 0
    v_mov_b32 v37, 0
    v_mov_b32 v38, 0
    v_mov_b32 v39, 0
    v_mov_b32 v40, 0
    v_mov_b32 v41, 0
    v_mov_b32 v42, 0
    v_mov_b32 v43, 0
    v_mov_b32 v7, 0
    v_mov_b32 v6, 0xff7fffff
    s_cmp_lt_u32 s59, s60
    s_cbranch_scc1 L_flush
    ds_read_b128 v[8:11], v5 offset:0
    ds_read_b128 v[12:15], v5 offset:128
    ds_read_b128 v[16:19], v5 offset:256
    s_waitcnt lgkmcnt(0)
    s_cmp_eq_u32 s6, 0
    s_cbranch_scc1 L_next
    s_branch L_small0
L_trans:
    s_mov_b64 s[8:9], s[24:25]
    s_mov_b64 s[12:13], s[26:27]
    s_mov_b64 exec, 1
    ds_add_rtn_u32 v224, v223, v227 offset:16
    s_mov_b64 exec, -1
    s_add_u32 s79, s79, 460
    s_lshl_b32 s79, s79, 2
    s_add_u32 s72, s7, s79
    s_and_b32 s72, s72, 1023
    s_mul_i32 s72, s72, 3072
    s_add_u32 s7, s58, 301989888
    s_add_u32 s79, s79, 32
    s_add_u32 s56, s7, s72
    s_mov_b32 s6, 1
    s_mov_b32 s60, 3
    buffer_load_dwordx4 v[68:71], v1, s[8:11], s56 offen offset:0 nt
    buffer_load_dwordx4 v[72:75], v1, s[8:11], s56 offen offset:128 nt
    buffer_load_dwordx4 v[76:79], v1, s[8:11], s56 offen offset:256 nt
    v_dot2c_f32_bf16 v20, v92, v60
    v_dot2c_f32_bf16 v21, v92, v61
    v_dot2c_f32_bf16 v22, v93, v60
    v_dot2c_f32_bf16 v23, v93, v61
    v_dot2c_f32_bf16 v24, v94, v60
    v_dot2c_f32_bf16 v25, v94, v61
    v_dot2c_f32_bf16 v26, v95, v60
    v_dot2c_f32_bf16 v27, v95, v61
    v_dot2c_f32_bf16 v28, v96, v60
    v_dot2c_f32_bf16 v29, v96, v61
    v_dot2c_f32_bf16 v30, v97, v60
    v_dot2c_f32_bf16 v31, v97, v61
    v_dot2c_f32_bf16 v32, v98, v60
    v_dot2c_f32_bf16 v33, v98, v61
    v_dot2c_f32_bf16 v34, v99, v60
    v_dot2c_f32_bf16 v35, v99, v61
    v_dot2c_f32_bf16 v36, v100, v60
    v_dot2c_f32_bf16 v37, v100, v61
    v_dot2c_f32_bf16 v38, v101, v60
    v_dot2c_f32_bf16 v39, v101, v61
    v_dot2c_f32_bf16 v40, v102, v60
    v_dot2c_f32_bf16 v41, v102, v61
    v_dot2c_f32_bf16 v42, v103, v60
    v_dot2c_f32_bf16 v43, v103, v61
    s_waitcnt lgkmcnt(0)
    v_readfirstlane_b32 s76, v224
    s_nop 1
    s_and_b32 s72, s76, 3
    s_cbranch_scc1 L_tr
    v_mov_b32 v220, 1
    s_mov_b64 exec, 1
    buffer_atomic_add v220, v3, s[16:19], 0 offen offset:128 sc0 sc1
    s_mov_b64 exec, -1
    s_waitcnt vmcnt(4)
    s_branch L_trd
L_tr:
    s_waitcnt vmcnt(3)
L_trd:
    buffer_load_dwordx4 v[80:83], v1, s[12:15], s56 offen offset:0 nt
    buffer_load_dwordx4 v[84:87], v1, s[12:15], s56 offen offset:128 nt
    buffer_load_dwordx4 v[88:91], v1, s[12:15], s56 offen offset:256 nt
    v_dot2c_f32_bf16 v20, v104, v62
    v_dot2c_f32_bf16 v21, v104, v63
    v_dot2c_f32_bf16 v22, v105, v62
    v_dot2c_f32_bf16 v23, v105, v63
    v_dot2c_f32_bf16 v24, v106, v62
    v_dot2c_f32_bf16 v25, v106, v63
    v_dot2c_f32_bf16 v26, v107, v62
    v_dot2c_f32_bf16 v27, v107, v63
    v_dot2c_f32_bf16 v28, v108, v62
    v_dot2c_f32_bf16 v29, v108, v63
    v_dot2c_f32_bf16 v30, v109, v62
    v_dot2c_f32_bf16 v31, v109, v63
    v_dot2c_f32_bf16 v32, v110, v62
    v_dot2c_f32_bf16 v33, v110, v63
    v_dot2c_f32_bf16 v34, v111, v62
    v_dot2c_f32_bf16 v35, v111, v63
    v_dot2c_f32_bf16 v36, v112, v62
    v_dot2c_f32_bf16 v37, v112, v63
    v_dot2c_f32_bf16 v38, v113, v62
    v_dot2c_f32_bf16 v39, v113, v63
    v_dot2c_f32_bf16 v40, v114, v62
    v_dot2c_f32_bf16 v41, v114, v63
    v_dot2c_f32_bf16 v42, v115, v62
    v_dot2c_f32_bf16 v43, v115, v63
    s_cmp_lg_u32 s59, 3
    s_cbranch_scc1 L_flush
L_small0:
    s_mul_i32 s72, s59, 784
    s_add_u32 s72, s72, 99840
    v_and_b32 v51, 31, v0
    v_lshlrev_b32 v54, 4, v51
    v_add_u32 v46, s72, v54
    v_mov_b32 v47, s72
    v_lshl_add_u32 v51, v51, 3, s72
    v_mov_b32 v55, 0xffff
    v_and_b32 v50, 1, v0
    v_lshlrev_b32 v50, 4, v50
    v_lshrrev_b32 v49, v50, s64
    v_sub_u32 v50, 16, v50
    s_lshl_b32 s83, s59, 17
    s_lshl_b32 s72, s2, 9
    s_add_u32 s83, s83, s72
    s_add_u32 s83, s83, 1048576
    v_and_b32 v48, 7, v0
    v_lshlrev_b32 v48, 5, v48
    v_lshrrev_b32 v53, 4, v0
    v_lshl_add_u32 v48, v53, 3, v48
    v_add_u32 v48, s61, v48
    v_mov_b32 v53, s61
    v_mov_b32 v57, 0x7fc00000
    s_and_b32 s72, s76, 3
    s_cbranch_scc1 L_sm0
    s_waitcnt vmcnt(3)
L_sm0:
    s_and_b32 s72, s76, -4
    s_add_u32 s72, s72, 119616
    v_mov_b32 v225, s72
    s_and_b32 s72, s76, 3
    s_cbranch_scc1 L_sq0
    s_waitcnt vmcnt(6)
    s_mov_b64 exec, 1
    v_lshlrev_b32 v220, 2, v220
    v_add_u32 v220, 1, v220
    ds_write_b32 v225, v220
    s_mov_b64 exec, -1
    v_readfirstlane_b32 s72, v220
L_sq0r:
    s_and_b32 s73, s76, 3
    s_add_u32 s72, s72, s73
    s_sub_u32 s72, s72, 1
    s_cmp_ge_u32 s72, 96
    s_cbranch_scc1 L_nd0
    s_mov_b64 exec, 1
    ds_add_rtn_u32 v224, v223, v227 offset:16
    s_mov_b64 exec, -1
    s_add_u32 s73, s72, s79
    s_and_b32 s73, s73, 1023
    s_mul_i32 s73, s73, 3072
    s_add_u32 s56, s73, s7
    s_waitcnt lgkmcnt(0)
    v_readfirstlane_b32 s76, v224
    s_nop 1
    s_and_b32 s73, s76, 3
    s_cbranch_scc0 L_cl0
    s_cmp_ge_u32 s72, 96
L_nd0:
    s_waitcnt vmcnt(3)
    s_cbranch_scc1 L_nk0
L_ik0:
    buffer_load_dwordx4 v[92:95], v1, s[8:11], s56 offen offset:0 nt
    buffer_load_dwordx4 v[96:99], v1, s[8:11], s56 offen offset:128 nt
    buffer_load_dwordx4 v[100:103], v1, s[8:11], s56 offen offset:256 nt
L_nk0:
    v_dot2_f32_bf16 v44, v68, v8, 0
    v_dot2_f32_bf16 v45, v69, v9, 0
    v_dot2_f32_bf16 v44, v70, v10, v44
    v_dot2_f32_bf16 v45, v71, v11, v45
    v_dot2_f32_bf16 v44, v72, v12, v44
    v_dot2_f32_bf16 v45, v73, v13, v45
    v_dot2_f32_bf16 v44, v74, v14, v44
    v_dot2_f32_bf16 v45, v75, v15, v45
    v_dot2_f32_bf16 v44, v76, v16, v44
    v_dot2_f32_bf16 v45, v77, v17, v45
    v_dot2_f32_bf16 v44, v78, v18, v44
    v_dot2_f32_bf16 v45, v79, v19, v45
    s_nop 2
    v_add_f32 v52, v44, v45
    s_nop 1
    v_add_f32_dpp v52, v52, v52 quad_perm:[1,0,3,2] row_mask:0xf bank_mask:0xf
    s_nop 1
    v_add_f32_dpp v52, v52, v52 quad_perm:[2,3,0,1] row_mask:0xf bank_mask:0xf
    s_nop 1
    v_add_f32_dpp v52, v52, v52 row_half_mirror row_mask:0xf bank_mask:0xf
    v_cvt_pk_bf16_f32 v52, 0, v52
    v_mul_f32 v52, 0x3d93cd3a, v52
    v_cvt_pk_bf16_f32 v52, 0, v52
    v_mul_f32 v64, s71, v52
    v_cmp_nle_f32 vcc, v64, v57
    s_cbranch_vccnz L_nm0
L_mo0:
    v_fma_f32 v52, v52, s71, -v6
    v_exp_f32 v52, v52
    s_cmp_ge_u32 s72, 96
    v_cvt_pk_bf16_f32 v58, v52, 0
    v_cvt_pk_bf16_f32 v59, 0, v52
    v_add_f32 v7, v7, v59
    s_cbranch_scc0 L_nl0
    s_waitcnt vmcnt(0)
L_vd0:
    v_dot2c_f32_bf16 v20, v80, v58
    v_dot2c_f32_bf16 v21, v80, v59
    v_dot2c_f32_bf16 v22, v81, v58
    v_dot2c_f32_bf16 v23, v81, v59
    v_dot2c_f32_bf16 v24, v82, v58
    v_dot2c_f32_bf16 v25, v82, v59
    v_dot2c_f32_bf16 v26, v83, v58
    v_dot2c_f32_bf16 v27, v83, v59
    v_dot2c_f32_bf16 v28, v84, v58
    v_dot2c_f32_bf16 v29, v84, v59
    v_dot2c_f32_bf16 v30, v85, v58
    v_dot2c_f32_bf16 v31, v85, v59
    v_dot2c_f32_bf16 v32, v86, v58
    v_dot2c_f32_bf16 v33, v86, v59
    v_dot2c_f32_bf16 v34, v87, v58
    v_dot2c_f32_bf16 v35, v87, v59
    v_dot2c_f32_bf16 v36, v88, v58
    v_dot2c_f32_bf16 v37, v88, v59
    v_dot2c_f32_bf16 v38, v89, v58
    v_dot2c_f32_bf16 v39, v89, v59
    v_dot2c_f32_bf16 v40, v90, v58
    v_dot2c_f32_bf16 v41, v90, v59
    v_dot2c_f32_bf16 v42, v91, v58
    v_dot2c_f32_bf16 v43, v91, v59
    s_cmp_ge_u32 s72, 96
    s_cbranch_scc1 L_flush2
L_sm1:
    s_and_b32 s72, s76, -4
    s_add_u32 s72, s72, 119616
    v_mov_b32 v225, s72
    s_and_b32 s72, s76, 3
    s_cbranch_scc1 L_sq1
    s_waitcnt vmcnt(6)
    s_mov_b64 exec, 1
    v_lshlrev_b32 v220, 2, v220
    v_add_u32 v220, 1, v220
    ds_write_b32 v225, v220
    s_mov_b64 exec, -1
    v_readfirstlane_b32 s72, v220
L_sq1r:
    s_and_b32 s73, s76, 3
    s_add_u32 s72, s72, s73
    s_sub_u32 s72, s72, 1
    s_cmp_ge_u32 s72, 96
    s_cbranch_scc1 L_nd1
    s_mov_b64 exec, 1
    ds_add_rtn_u32 v224, v223, v227 offset:16
    s_mov_b64 exec, -1
    s_add_u32 s73, s72, s79
    s_and_b32 s73, s73, 1023
    s_mul_i32 s73, s73, 3072
    s_add_u32 s56, s73, s7
    s_waitcnt lgkmcnt(0)
    v_readfirstlane_b32 s76, v224
    s_nop 1
    s_and_b32 s73, s76, 3
    s_cbranch_scc0 L_cl1
    s_cmp_ge_u32 s72, 96
L_nd1:
    s_waitcnt vmcnt(3)
    s_cbranch_scc1 L_nk1
L_ik1:
    buffer_load_dwordx4 v[68:71], v1, s[8:11], s56 offen offset:0 nt
    buffer_load_dwordx4 v[72:75], v1, s[8:11], s56 offen offset:128 nt
    buffer_load_dwordx4 v[76:79], v1, s[8:11], s56 offen offset:256 nt
L_nk1:
    v_dot2_f32_bf16 v44, v92, v8, 0
    v_dot2_f32_bf16 v45, v93, v9, 0
    v_dot2_f32_bf16 v44, v94, v10, v44
    v_dot2_f32_bf16 v45, v95, v11, v45
    v_dot2_f32_bf16 v44, v96, v12, v44
    v_dot2_f32_bf16 v45, v97, v13, v45
    v_dot2_f32_bf16 v44, v98, v14, v44
    v_dot2_f32_bf16 v45, v99, v15, v45
    v_dot2_f32_bf16 v44, v100, v16, v44
    v_dot2_f32_bf16 v45, v101, v17, v45
    v_dot2_f32_bf16 v44, v102, v18, v44
    v_dot2_f32_bf16 v45, v103, v19, v45
    s_nop 2
    v_add_f32 v52, v44, v45
    s_nop 1
    v_add_f32_dpp v52, v52, v52 quad_perm:[1,0,3,2] row_mask:0xf bank_mask:0xf
    s_nop 1
    v_add_f32_dpp v52, v52, v52 quad_perm:[2,3,0,1] row_mask:0xf bank_mask:0xf
    s_nop 1
    v_add_f32_dpp v52, v52, v52 row_half_mirror row_mask:0xf bank_mask:0xf
    v_cvt_pk_bf16_f32 v52, 0, v52
    v_mul_f32 v52, 0x3d93cd3a, v52
    v_cvt_pk_bf16_f32 v52, 0, v52
    v_mul_f32 v64, s71, v52
    v_cmp_nle_f32 vcc, v64, v57
    s_cbranch_vccnz L_nm1
L_mo1:
    v_fma_f32 v52, v52, s71, -v6
    v_exp_f32 v52, v52
    s_cmp_ge_u32 s72, 96
    v_cvt_pk_bf16_f32 v58, v52, 0
    v_cvt_pk_bf16_f32 v59, 0, v52
    v_add_f32 v7, v7, v59
    s_cbranch_scc0 L_nl1
    s_waitcnt vmcnt(0)
L_vd1:
    v_dot2c_f32_bf16 v20, v104, v58
    v_dot2c_f32_bf16 v21, v104, v59
    v_dot2c_f32_bf16 v22, v105, v58
    v_dot2c_f32_bf16 v23, v105, v59
    v_dot2c_f32_bf16 v24, v106, v58
    v_dot2c_f32_bf16 v25, v106, v59
    v_dot2c_f32_bf16 v26, v107, v58
    v_dot2c_f32_bf16 v27, v107, v59
    v_dot2c_f32_bf16 v28, v108, v58
    v_dot2c_f32_bf16 v29, v108, v59
    v_dot2c_f32_bf16 v30, v109, v58
    v_dot2c_f32_bf16 v31, v109, v59
    v_dot2c_f32_bf16 v32, v110, v58
    v_dot2c_f32_bf16 v33, v110, v59
    v_dot2c_f32_bf16 v34, v111, v58
    v_dot2c_f32_bf16 v35, v111, v59
    v_dot2c_f32_bf16 v36, v112, v58
    v_dot2c_f32_bf16 v37, v112, v59
    v_dot2c_f32_bf16 v38, v113, v58
    v_dot2c_f32_bf16 v39, v113, v59
    v_dot2c_f32_bf16 v40, v114, v58
    v_dot2c_f32_bf16 v41, v114, v59
    v_dot2c_f32_bf16 v42, v115, v58
    v_dot2c_f32_bf16 v43, v115, v59
    s_cmp_ge_u32 s72, 96
    s_cbranch_scc1 L_flush2
    s_branch L_sm0
L_nl0:
    s_waitcnt vmcnt(4)
    s_and_b32 s73, s76, 3
    s_cbranch_scc0 L_nv0
    s_waitcnt vmcnt(3)
L_nv0:
    buffer_load_dwordx4 v[104:107], v1, s[12:15], s56 offen offset:0 nt
    buffer_load_dwordx4 v[108:111], v1, s[12:15], s56 offen offset:128 nt
    buffer_load_dwordx4 v[112:115], v1, s[12:15], s56 offen offset:256 nt
    s_branch L_vd0
L_cl0:
    v_mov_b32 v220, 1
    s_mov_b64 exec, 1
    buffer_atomic_add v220, v3, s[16:19], 0 offen offset:128 sc0 sc1
    s_mov_b64 exec, -1
    s_waitcnt vmcnt(4)
    s_branch L_ik0
L_nm0:
    v_max_f32 v64, v64, v6
    s_nop 1
    v_max_f32_dpp v64, v64, v64 row_ror:8 row_mask:0xf bank_mask:0xf
    v_mov_b32 v67, v64
    s_nop 1
    v_permlane16_swap_b32 v64, v67
    v_max_f32 v64, v64, v67
    v_mov_b32 v67, v64
    s_nop 1
    v_permlane32_swap_b32 v64, v67
    v_max_f32 v64, v64, v67
    v_sub_f32 v66, v6, v64
    v_exp_f32 v66, v66
    v_mov_b32 v6, v64
    v_mul_f32 v7, v7, v66
    v_pk_mul_f32 v[20:21], v[20:21], v[66:67] op_sel_hi:[1,0]
    v_pk_mul_f32 v[22:23], v[22:23], v[66:67] op_sel_hi:[1,0]
    v_pk_mul_f32 v[24:25], v[24:25], v[66:67] op_sel_hi:[1,0]
    v_pk_mul_f32 v[26:27], v[26:27], v[66:67] op_sel_hi:[1,0]
    v_pk_mul_f32 v[28:29], v[28:29], v[66:67] op_sel_hi:[1,0]
    v_pk_mul_f32 v[30:31], v[30:31], v[66:67] op_sel_hi:[1,0]
    v_pk_mul_f32 v[32:33], v[32:33], v[66:67] op_sel_hi:[1,0]
    v_pk_mul_f32 v[34:35], v[34:35], v[66:67] op_sel_hi:[1,0]
    v_pk_mul_f32 v[36:37], v[36:37], v[66:67] op_sel_hi:[1,0]
    v_pk_mul_f32 v[38:39], v[38:39], v[66:67] op_sel_hi:[1,0]
    v_pk_mul_f32 v[40:41], v[40:41], v[66:67] op_sel_hi:[1,0]
    v_pk_mul_f32 v[42:43], v[42:43], v[66:67] op_sel_hi:[1,0]
    v_mov_b32 v57, v6
    s_branch L_mo0
L_nl1:
    s_waitcnt vmcnt(4)
    s_and_b32 s73, s76, 3
    s_cbranch_scc0 L_nv1
    s_waitcnt vmcnt(3)
L_nv1:
    buffer_load_dwordx4 v[80:83], v1, s[12:15], s56 offen offset:0 nt
    buffer_load_dwordx4 v[84:87], v1, s[12:15], s56 offen offset:128 nt
    buffer_load_dwordx4 v[88:91], v1, s[12:15], s56 offen offset:256 nt
    s_branch L_vd1
L_cl1:
    v_mov_b32 v220, 1
    s_mov_b64 exec, 1
    buffer_atomic_add v220, v3, s[16:19], 0 offen offset:128 sc0 sc1
    s_mov_b64 exec, -1
    s_waitcnt vmcnt(4)
    s_branch L_ik1
L_nm1:
    v_max_f32 v64, v64, v6
    s_nop 1
    v_max_f32_dpp v64, v64, v64 row_ror:8 row_mask:0xf bank_mask:0xf
    v_mov_b32 v67, v64
    s_nop 1
    v_permlane16_swap_b32 v64, v67
    v_max_f32 v64, v64, v67
    v_mov_b32 v67, v64
    s_nop 1
    v_permlane32_swap_b32 v64, v67
    v_max_f32 v64, v64, v67
    v_sub_f32 v66, v6, v64
    v_exp_f32 v66, v66
    v_mov_b32 v6, v64
    v_mul_f32 v7, v7, v66
    v_pk_mul_f32 v[20:21], v[20:21], v[66:67] op_sel_hi:[1,0]
    v_pk_mul_f32 v[22:23], v[22:23], v[66:67] op_sel_hi:[1,0]
    v_pk_mul_f32 v[24:25], v[24:25], v[66:67] op_sel_hi:[1,0]
    v_pk_mul_f32 v[26:27], v[26:27], v[66:67] op_sel_hi:[1,0]
    v_pk_mul_f32 v[28:29], v[28:29], v[66:67] op_sel_hi:[1,0]
    v_pk_mul_f32 v[30:31], v[30:31], v[66:67] op_sel_hi:[1,0]
    v_pk_mul_f32 v[32:33], v[32:33], v[66:67] op_sel_hi:[1,0]
    v_pk_mul_f32 v[34:35], v[34:35], v[66:67] op_sel_hi:[1,0]
    v_pk_mul_f32 v[36:37], v[36:37], v[66:67] op_sel_hi:[1,0]
    v_pk_mul_f32 v[38:39], v[38:39], v[66:67] op_sel_hi:[1,0]
    v_pk_mul_f32 v[40:41], v[40:41], v[66:67] op_sel_hi:[1,0]
    v_pk_mul_f32 v[42:43], v[42:43], v[66:67] op_sel_hi:[1,0]
    v_mov_b32 v57, v6
    s_branch L_mo1
L_sp0k:
    s_mov_b64 exec, 1
    ds_read_b32 v226, v225
    s_mov_b64 exec, -1
    s_waitcnt lgkmcnt(0)
    v_readfirstlane_b32 s72, v226
    s_nop 1
    s_cmp_eq_u32 s72, 0
    s_cbranch_scc1 L_sp0k
    s_branch L_sp0kr
L_sp0v:
    s_mov_b64 exec, 1
    ds_read_b32 v226, v225
    s_mov_b64 exec, -1
    s_waitcnt lgkmcnt(0)
    v_readfirstlane_b32 s72, v226
    s_nop 1
    s_cmp_eq_u32 s72, 0
    s_cbranch_scc1 L_sp0v
    s_branch L_sp0vr
L_sp0:
    s_mov_b64 exec, 1
    ds_read_b32 v226, v225
    s_mov_b64 exec, -1
    s_waitcnt lgkmcnt(0)
    v_readfirstlane_b32 s72, v226
    s_nop 1
    s_cmp_eq_u32 s72, 0
    s_cbranch_scc1 L_sp0
    s_branch L_sp0r
L_sq0:
    s_mov_b64 exec, 1
    ds_read_b32 v226, v225
    s_mov_b64 exec, -1
    s_waitcnt lgkmcnt(0)
    v_readfirstlane_b32 s72, v226
    s_nop 1
    s_cmp_eq_u32 s72, 0
    s_cbranch_scc1 L_sq0
    s_branch L_sq0r
L_sq1:
    s_mov_b64 exec, 1
    ds_read_b32 v226, v225
    s_mov_b64 exec, -1
    s_waitcnt lgkmcnt(0)
    v_readfirstlane_b32 s72, v226
    s_nop 1
    s_cmp_eq_u32 s72, 0
    s_cbranch_scc1 L_sq1
    s_branch L_sq1r
L_fin:
L_end:
    s_endpgm
.section .rodata,"a"
.p2align 6
.amdhsa_kernel sequential_preLN__mha_block_cached__dense_activation_gelu__decode_kernel
  .amdhsa_next_free_vgpr 256
  .amdhsa_next_free_sgpr 102
  .amdhsa_accum_offset 256
  .amdhsa_group_segment_fixed_size 0
  .amdhsa_kernarg_size 104
  .amdhsa_user_sgpr_count 2
  .amdhsa_user_sgpr_kernarg_segment_ptr 1
  .amdhsa_system_sgpr_workgroup_id_x 1
.end_amdhsa_kernel
```
